```python
import torch

def _softmax(x, axis=-1):
    return torch.softmax(x, dim=axis)
def _gelu(x):
    return torch.nn.functional.gelu(x, approximate="tanh")
def _silu(x):
    return torch.nn.functional.silu(x)
def _sigmoid(x):
    return torch.sigmoid(x)
def _layernorm(x, axis=-1, eps=1e-5):
    m = x.mean(dim=axis, keepdim=True)
    v = x.var(dim=axis, keepdim=True, unbiased=False)
    return (x - m) / torch.sqrt(v + eps)
def _scatter_add(tgt, idx, src, axis=0):
    return tgt.clone().index_add_(axis, idx, src)
def _segment_sum(src, seg, n):
    out = torch.zeros((n,) + src.shape[1:], dtype=src.dtype)
    return out.index_add_(0, seg, src)
def _pad(x, pw):
    flat = tuple(v for pair in reversed(pw) for v in pair)
    return torch.nn.functional.pad(x, flat)

kernel_name = 'standalone__edge_featured_mpnn_gatedgcn__graph'

def setup_inputs():

    _w = (lambda a: (lambda t: t.to(torch.bfloat16) if t.is_floating_point() else t)(torch.as_tensor(a)))
    N, deg, D, De = 25000, 32, 64, max(4, 1)
    E = N * deg
    return {
        "x": _w((lambda *s: torch.randn(*s, dtype=torch.bfloat16) * 0.8)(N, D)),
        "e_attr": _w((lambda *s: torch.randn(*s, dtype=torch.bfloat16) * 0.8)(E, De)),
        "src": _w((lambda lo, hi, *s: torch.randint(lo, hi, s))(0, N, E).to(torch.int64)),
        "dst": _w((lambda lo, hi, *s: torch.randint(lo, hi, s))(0, N, E).to(torch.int64)),
        "w_a": _w((lambda *s: torch.randn(*s, dtype=torch.bfloat16) * 0.8)(D, D)),
        "w_b": _w((lambda *s: torch.randn(*s, dtype=torch.bfloat16) * 0.8)(D, D)),
        "w_c": _w((lambda *s: torch.randn(*s, dtype=torch.bfloat16) * 0.8)(De, D)),
        "w_u": _w((lambda *s: torch.randn(*s, dtype=torch.bfloat16) * 0.05)(D, D)),
        "w_v": _w((lambda *s: torch.randn(*s, dtype=torch.bfloat16) * 0.05)(D, D)),
    }

def reference(x, e_attr, src, dst, w_a, w_b, w_c, w_u, w_v):
    N, D = x.shape
    hv = x @ w_v
    g = x[dst] @ w_a + x[src] @ w_b + e_attr @ w_c
    eta = _sigmoid(g)
    denom = _segment_sum(eta, dst, N) + 1e-6
    eta_n = eta / denom[dst]
    agg = _segment_sum(eta_n * hv[src], dst, N)
    z = x @ w_u + agg
    relu_z = torch.where(z > 0, z, 0 * z)
    return x + relu_z
```

```asm
; @launch kernel=standalone__edge_featured_mpnn_gatedgcn__graph_kernel grid=(256,1,1) block=(512,1,1) lds=160800
.amdgcn_target "amdgcn-amd-amdhsa--gfx950"
.text
.globl standalone__edge_featured_mpnn_gatedgcn__graph_kernel
.type standalone__edge_featured_mpnn_gatedgcn__graph_kernel,@function
    .p2align 8
standalone__edge_featured_mpnn_gatedgcn__graph_kernel:
    s_cmp_ge_u32 s2, 256
    s_cbranch_scc1 K2_END
    s_load_dwordx8 s[44:51], s[0:1], 0
    s_load_dwordx8 s[52:59], s[0:1], 64
    s_load_dwordx8 s[60:67], s[0:1], 32
    s_mov_b32 s3, s2
    s_and_b32 s39, s2, 7
    s_lshr_b32 s2, s2, 3
    s_lshl_b32 s39, s39, 5
    s_or_b32 s2, s2, s39
    v_and_b32 v1, 63, v0
    v_lshrrev_b32 v2, 6, v0
    s_mul_i32 s39, s3, 12544
    v_readfirstlane_b32 s26, v2
    v_lshl_add_u32 v64, v2, 10, s39
    v_lshl_add_u32 v64, v1, 3, v64
    v_add_u32 v65, 7168, v64
    v_lshlrev_b32 v66, 1, v64
    v_lshlrev_b32 v67, 1, v65
    s_add_u32 s40, s39, 12544
    s_min_u32 s40, s40, 3200000
    s_sub_u32 s42, s40, 512
    v_cmp_gt_u32 s[76:77], s40, v64
    v_cmp_gt_u32 s[78:79], s42, v64
    v_cmp_gt_u32 s[32:33], s40, v65
    v_cmp_gt_u32 s[36:37], s42, v65
    v_lshlrev_b32 v68, 4, v1
    v_add_u32 v69, 125952, v68
    v_lshrrev_b32 v248, 2, v1
    v_and_b32 v249, 48, v68
    v_lshl_or_b32 v248, v248, 14, v249
    v_mov_b32 v72, 0
    v_mov_b32 v73, 0
    v_mov_b32 v74, 0
    v_mov_b32 v75, 0
    s_cmp_eq_u32 s26, 7
    s_cselect_b64 s[80:81], -1, 0
    s_andn2_b64 s[76:77], s[76:77], s[80:81]
    s_andn2_b64 s[78:79], s[78:79], s[80:81]
    s_mov_b64 exec, s[80:81]
    ds_write_b128 v69, v[72:75]
    ds_write_b128 v68, v[72:75] offset:0
    ds_write_b128 v68, v[72:75] offset:48
    s_mul_i32 s24, s2, 6399988
    s_add_u32 s25, s24, 6465523
    s_add_u32 s24, s24, 65535
    s_lshr_b32 s24, s24, 16
    s_lshr_b32 s25, s25, 16
    s_sub_u32 s25, s25, s24
    s_mov_b32 s27, 0
    s_movk_i32 s28, 384
    s_mov_b32 s29, 1
    s_mul_i32 s35, s26, 4352
    s_add_u32 s35, s35, 73728
    s_waitcnt lgkmcnt(0)
    s_mov_b32 s68, s50
    s_and_b32 s69, s51, 0xffff
    s_mov_b32 s70, 3200000
    s_mov_b32 s71, 0x20000
    s_mov_b64 exec, s[76:77]
    buffer_load_dwordx2 v[192:193], v64, s[68:71], 0 offen offset:0 nt
    s_mov_b64 exec, s[78:79]
    buffer_load_dwordx2 v[194:195], v64, s[68:71], 0 offen offset:512 nt
    s_mov_b64 exec, s[32:33]
    buffer_load_dwordx2 v[196:197], v65, s[68:71], 0 offen offset:0 nt
    s_mov_b64 exec, s[36:37]
    buffer_load_dwordx2 v[198:199], v65, s[68:71], 0 offen offset:512 nt
    s_mov_b32 s12, s58
    s_and_b32 s13, s59, 0xffff
    s_mov_b32 s14, 268435456
    s_mov_b32 s15, 0x20000
    s_cmp_lt_u32 s3, 64
    s_cselect_b64 exec, s[80:81], 0
    s_cbranch_execz P1_NOCL
    s_mul_i32 s39, s3, 4096
    buffer_store_dwordx4 v[72:75], v68, s[12:15], s39 offen offset:0 sc1
    buffer_store_dwordx4 v[72:75], v68, s[12:15], s39 offen offset:1024 sc1
    buffer_store_dwordx4 v[72:75], v68, s[12:15], s39 offen offset:2048 sc1
    buffer_store_dwordx4 v[72:75], v68, s[12:15], s39 offen offset:3072 sc1
P1_NOCL:
    s_mov_b32 s72, s48
    s_and_b32 s73, s49, 0xffff
    s_mov_b32 s74, 3200000
    s_mov_b32 s75, 0x20000
    s_mov_b32 s16, s46
    s_and_b32 s17, s47, 0xffff
    s_mov_b32 s18, 6400000
    s_mov_b32 s19, 0x20000
    s_barrier
    s_mov_b64 exec, s[76:77]
    buffer_load_dwordx2 v[200:201], v64, s[72:75], 0 offen offset:0 nt
    buffer_load_dwordx4 v[208:211], v66, s[16:19], 0 offen offset:0 nt
    s_mov_b64 exec, s[78:79]
    buffer_load_dwordx2 v[202:203], v64, s[72:75], 0 offen offset:512 nt
    buffer_load_dwordx4 v[212:215], v66, s[16:19], 0 offen offset:1024 nt
    s_mov_b64 exec, -1
    s_mov_b32 s20, s56
    s_and_b32 s21, s57, 0xffff
    s_mov_b32 s22, 256
    s_mov_b32 s23, 0x20000
    s_mov_b32 s8, s44
    s_and_b32 s9, s45, 0xffff
    s_mov_b32 s10, 3200000
    s_mov_b32 s11, 0x20000
    s_sub_u32 s50, s44, 3072
    s_subb_u32 s51, s45, 0
    s_mov_b32 s4, s50
    s_and_b32 s5, s51, 0xffff
    s_mov_b32 s6, 3203072
    s_mov_b32 s7, 0x20000
    s_movk_i32 s30, 128
    v_lshrrev_b32 v81, 5, v1
    v_and_b32 v77, 7, v1
    v_lshlrev_b32 v78, 2, v81
    v_xor_b32 v77, v77, v78
    v_and_b32 v82, 16, v1
    v_lshlrev_b32 v82, 2, v82
    v_xor_b32 v82, v68, v82
    s_cmp_eq_u32 s26, 7
    s_cbranch_scc1 P1_W7A
    v_mov_b32 v70, 12
    s_mov_b32 s39, 171799
    s_movk_i32 s42, 0x3fc
    v_mov_b32 v71, 125952
    s_mov_b64 exec, s[76:77]
    s_waitcnt vmcnt(7)
    v_mul_u32_u24 v224, s39, v192
    v_mul_u32_u24 v225, s39, v193
    v_lshrrev_b32 v224, 22, v224
    v_lshrrev_b32 v225, 22, v225
    v_and_or_b32 v224, v224, s42, v71
    ds_add_rtn_u32 v232, v224, v70
    v_and_or_b32 v225, v225, s42, v71
    ds_add_rtn_u32 v233, v225, v70
    v_and_b32 v192, 127, v192
    v_and_b32 v193, 127, v193
    s_mov_b64 exec, s[78:79]
    s_waitcnt vmcnt(6)
    v_mul_u32_u24 v226, s39, v194
    v_mul_u32_u24 v227, s39, v195
    v_lshrrev_b32 v226, 22, v226
    v_lshrrev_b32 v227, 22, v227
    v_and_or_b32 v226, v226, s42, v71
    ds_add_rtn_u32 v234, v226, v70
    v_and_or_b32 v227, v227, s42, v71
    ds_add_rtn_u32 v235, v227, v70
    v_and_b32 v194, 127, v194
    v_and_b32 v195, 127, v195
    s_mov_b64 exec, s[32:33]
    s_waitcnt vmcnt(5)
    v_mul_u32_u24 v228, s39, v196
    v_mul_u32_u24 v229, s39, v197
    v_lshrrev_b32 v228, 22, v228
    v_lshrrev_b32 v229, 22, v229
    v_and_or_b32 v228, v228, s42, v71
    ds_add_rtn_u32 v236, v228, v70
    v_and_or_b32 v229, v229, s42, v71
    ds_add_rtn_u32 v237, v229, v70
    v_and_b32 v196, 127, v196
    v_and_b32 v197, 127, v197
    s_mov_b64 exec, s[36:37]
    s_waitcnt vmcnt(4)
    v_mul_u32_u24 v230, s39, v198
    v_mul_u32_u24 v231, s39, v199
    v_lshrrev_b32 v230, 22, v230
    v_lshrrev_b32 v231, 22, v231
    v_and_or_b32 v230, v230, s42, v71
    ds_add_rtn_u32 v238, v230, v70
    v_and_or_b32 v231, v231, s42, v71
    ds_add_rtn_u32 v239, v231, v70
    v_and_b32 v198, 127, v198
    v_and_b32 v199, 127, v199
    s_mov_b64 exec, s[32:33]
    buffer_load_dwordx2 v[204:205], v65, s[72:75], 0 offen offset:0 nt
    buffer_load_dwordx4 v[216:219], v67, s[16:19], 0 offen offset:0 nt
    s_mov_b64 exec, s[36:37]
    buffer_load_dwordx2 v[206:207], v65, s[72:75], 0 offen offset:512 nt
    buffer_load_dwordx4 v[220:223], v67, s[16:19], 0 offen offset:1024 nt
    s_mov_b64 exec, -1
    s_waitcnt lgkmcnt(0)
    s_barrier
    ds_read_b128 v[240:243], v69
    s_waitcnt lgkmcnt(0)
    v_add_u32 v72, v240, v241
    v_add_u32 v73, v72, v242
    v_add_u32 v76, v73, v243
    v_mov_b32 v80, v76
    s_nop 1
    v_add_u32_dpp v80, v80, v80 row_shr:1 row_mask:0xf bank_mask:0xf
    s_nop 1
    v_add_u32_dpp v80, v80, v80 row_shr:2 row_mask:0xf bank_mask:0xf
    s_nop 1
    v_add_u32_dpp v80, v80, v80 row_shr:4 row_mask:0xf bank_mask:0xf
    s_nop 1
    v_add_u32_dpp v80, v80, v80 row_shr:8 row_mask:0xf bank_mask:0xf
    s_nop 1
    v_add_u32_dpp v80, v80, v80 row_bcast:15 row_mask:0xa bank_mask:0xf
    s_nop 1
    v_add_u32_dpp v80, v80, v80 row_bcast:31 row_mask:0xc bank_mask:0xf
    v_sub_u32 v244, v80, v76
    v_add_u32 v245, v244, v240
    v_add_u32 v246, v244, v72
    v_add_u32 v247, v244, v73
    ds_write_b128 v69, v[244:247] offset:1024
    s_waitcnt lgkmcnt(0)
    s_mov_b64 exec, s[76:77]
    ds_read_b32 v224, v224 offset:1024
    ds_read_b32 v225, v225 offset:1024
    s_mov_b64 exec, s[78:79]
    ds_read_b32 v226, v226 offset:1024
    ds_read_b32 v227, v227 offset:1024
    s_mov_b64 exec, s[32:33]
    ds_read_b32 v228, v228 offset:1024
    ds_read_b32 v229, v229 offset:1024
    s_mov_b64 exec, s[36:37]
    ds_read_b32 v230, v230 offset:1024
    ds_read_b32 v231, v231 offset:1024
    s_mov_b64 exec, -1
    s_lshl_b32 s40, s26, 10
    s_add_u32 m0, s40, 81920
    s_mov_b32 s68, s52
    s_and_b32 s69, s53, 0xffff
    s_mov_b32 s70, 8192
    s_mov_b32 s71, 0x20000
    buffer_load_dwordx4 v82, s[68:71], s40 offen lds
    s_add_u32 m0, s40, 90112
    s_mov_b32 s68, s60
    s_and_b32 s69, s61, 0xffff
    s_mov_b32 s70, 8192
    s_mov_b32 s71, 0x20000
    buffer_load_dwordx4 v82, s[68:71], s40 offen lds
    s_add_u32 m0, s40, 98304
    s_mov_b32 s68, s66
    s_and_b32 s69, s67, 0xffff
    s_mov_b32 s70, 8192
    s_mov_b32 s71, 0x20000
    buffer_load_dwordx4 v82, s[68:71], s40 offen lds
    s_lshl_b32 s40, s26, 10
    s_mov_b32 s68, s62
    s_and_b32 s69, s63, 0xffff
    s_mov_b32 s70, 8192
    s_mov_b32 s71, 0x20000
    buffer_load_dwordx4 v[112:115], v82, s[68:71], s40 offen
    v_and_b32 v67, 31, v1
    v_bfe_u32 v70, v1, 2, 1
    v_bfe_u32 v71, v1, 3, 2
    v_and_b32 v72, 1, v71
    v_lshlrev_b32 v72, 4, v72
    v_mov_b32 v73, 0x3f80
    v_cmp_eq_u32 vcc, v70, v81
    v_lshlrev_b32 v72, v72, v73
    v_cmp_gt_u32 s[42:43], 2, v71
    v_cndmask_b32 v72, 0, v72, vcc
    v_and_b32 v73, 3, v1
    v_cndmask_b32 v102, 0, v72, s[42:43]
    v_cndmask_b32 v103, v72, 0, s[42:43]
    v_mov_b32 v101, 0x3f80
    v_xor_b32 v74, 0, v77
    v_lshlrev_b32 v74, 4, v74
    v_add_u32 v60, 3072, v74
    v_xor_b32 v74, 1, v77
    v_lshlrev_b32 v74, 4, v74
    v_add_u32 v61, 2048, v74
    v_xor_b32 v74, 2, v77
    v_lshlrev_b32 v74, 4, v74
    v_add_u32 v62, 1024, v74
    v_xor_b32 v74, 3, v77
    v_lshlrev_b32 v74, 4, v74
    v_add_u32 v63, 0, v74
    v_bfe_u32 v74, v1, 2, 3
    v_bfe_u32 v75, v1, 4, 1
    v_lshl_add_u32 v72, v75, 2, v73
    v_lshlrev_b32 v76, 10, v73
    v_lshl_add_u32 v76, v74, 7, v76
    v_add_u32 v76, s35, v76
    v_xor_b32 v72, v72, v81
    v_xor_b32 v74, 0, v72
    v_lshl_add_u32 v20, v74, 4, v76
    v_xor_b32 v74, 2, v72
    v_lshl_add_u32 v21, v74, 4, v76
    v_xor_b32 v74, 4, v72
    v_lshl_add_u32 v22, v74, 4, v76
    v_xor_b32 v74, 6, v72
    v_lshl_add_u32 v23, v74, 4, v76
    v_lshlrev_b32 v17, 2, v75
    v_xor_b32 v17, v17, v67
    v_lshlrev_b32 v17, 4, v17
    v_add_u32 v17, 108544, v17
    v_mov_b32 v18, 0x27800000
    v_mov_b32 v16, 1056
    v_lshlrev_b32 v73, 3, v73
    v_lshl_add_u32 v7, v75, 5, v73
    s_and_b32 s41, s26, 1
    s_lshr_b32 s39, s26, 1
    s_lshl_b32 s40, s39, 5
    v_add_u32 v252, s40, v67
    v_mov_b32 v254, v252
    v_mul_u32_u24 v252, 136, v252
    v_lshl_add_u32 v252, v81, 3, v252
    s_lshl_b32 s41, s41, 6
    v_add_u32 v252, s41, v252
    v_bfe_u32 v71, v1, 2, 2
    v_lshl_add_u32 v253, v81, 2, v71
    v_lshl_add_u32 v253, v253, 7, v7
    v_add_u32 v253, 124928, v253
    v_lshl_add_u32 v249, v81, 3, v71
    v_lshl_add_u32 v249, v249, 7, v7
    v_bfe_u32 v71, v1, 3, 1
    v_lshl_add_u32 v249, v71, 6, v249
    v_add_u32 v249, 73728, v249
    v_xor_b32 v250, 64, v249
    v_xor_b32 v251, s41, v249
    s_mul_i32 s34, s26, 5120
    s_add_u32 s34, s34, 32768
    s_sub_u32 s39, s34, s35
    v_add_u32 v24, s39, v20
    v_add_u32 v25, s39, v21
    v_add_u32 v26, s39, v22
    v_add_u32 v27, s39, v23
    s_add_u32 s40, s40, s24
    v_lshrrev_b32 v71, 3, v1
    v_lshl_add_u32 v56, v71, 2, s40
    v_add_u32 v57, 1, v56
    v_add_u32 v58, 2, v56
    v_add_u32 v59, 3, v56
    v_mad_u32_u16 v56, v56, s30, v60
    v_mad_u32_u16 v57, v57, s30, v61
    v_mad_u32_u16 v58, v58, s30, v62
    v_mad_u32_u16 v59, v59, s30, v63
    s_movk_i32 s42, 32656
    s_waitcnt lgkmcnt(0)
    s_mov_b64 exec, s[76:77]
    s_waitcnt vmcnt(10)
    v_lshl_or_b32 v200, v192, 18, v200
    v_add3_u32 v224, v224, v232, s42
    ds_write_b32 v224, v200 offset:8
    ds_write2_b32 v224, v208, v209 offset0:0 offset1:1
    v_lshl_or_b32 v201, v193, 18, v201
    v_add3_u32 v225, v225, v233, s42
    ds_write_b32 v225, v201 offset:8
    ds_write2_b32 v225, v210, v211 offset0:0 offset1:1
    s_mov_b64 exec, s[78:79]
    s_waitcnt vmcnt(8)
    v_lshl_or_b32 v202, v194, 18, v202
    v_add3_u32 v226, v226, v234, s42
    ds_write_b32 v226, v202 offset:8
    ds_write2_b32 v226, v212, v213 offset0:0 offset1:1
    v_lshl_or_b32 v203, v195, 18, v203
    v_add3_u32 v227, v227, v235, s42
    ds_write_b32 v227, v203 offset:8
    ds_write2_b32 v227, v214, v215 offset0:0 offset1:1
    s_mov_b64 exec, s[32:33]
    s_waitcnt vmcnt(6)
    v_lshl_or_b32 v204, v196, 18, v204
    v_add3_u32 v228, v228, v236, s42
    ds_write_b32 v228, v204 offset:8
    ds_write2_b32 v228, v216, v217 offset0:0 offset1:1
    v_lshl_or_b32 v205, v197, 18, v205
    v_add3_u32 v229, v229, v237, s42
    ds_write_b32 v229, v205 offset:8
    ds_write2_b32 v229, v218, v219 offset0:0 offset1:1
    s_mov_b64 exec, s[36:37]
    s_waitcnt vmcnt(4)
    v_lshl_or_b32 v206, v198, 18, v206
    v_add3_u32 v230, v230, v238, s42
    ds_write_b32 v230, v206 offset:8
    ds_write2_b32 v230, v220, v221 offset0:0 offset1:1
    v_lshl_or_b32 v207, v199, 18, v207
    v_add3_u32 v231, v231, v239, s42
    ds_write_b32 v231, v207 offset:8
    ds_write2_b32 v231, v222, v223 offset0:0 offset1:1
    s_mov_b64 exec, -1
P1_J:
    v_lshlrev_b32 v64, 4, v0
    v_add_u32 v65, 32656, v64
    s_mul_i32 s39, s2, 37632
    s_add_u32 s39, s39, 524288
    s_movk_i32 s42, 304
    v_cmp_gt_u32 vcc, s42, v0
    s_waitcnt lgkmcnt(0)
    s_barrier
    ds_read_b128 v[192:195], v65 offset:0
    ds_read_b128 v[196:199], v65 offset:8192
    ds_read_b128 v[200:203], v65 offset:16384
    ds_read_b128 v[204:207], v65 offset:24576
    ds_read_b128 v[208:211], v65 offset:32768
    s_waitcnt lgkmcnt(4)
    buffer_store_dwordx4 v[192:195], v64, s[12:15], s39 offen sc1
    s_add_u32 s39, s39, 8192
    s_waitcnt lgkmcnt(3)
    buffer_store_dwordx4 v[196:199], v64, s[12:15], s39 offen sc1
    s_add_u32 s39, s39, 8192
    s_waitcnt lgkmcnt(2)
    buffer_store_dwordx4 v[200:203], v64, s[12:15], s39 offen sc1
    s_add_u32 s39, s39, 8192
    s_waitcnt lgkmcnt(1)
    buffer_store_dwordx4 v[204:207], v64, s[12:15], s39 offen sc1
    s_add_u32 s39, s39, 8192
    s_mov_b64 exec, vcc
    s_waitcnt lgkmcnt(0)
    buffer_store_dwordx4 v[208:211], v64, s[12:15], s39 offen sc1
    s_mov_b64 exec, -1
    s_cmp_eq_u32 s26, 7
    s_cbranch_scc1 P1_W7B
    s_mov_b32 s16, s54
    s_and_b32 s17, s55, 0xffff
    s_mov_b32 s18, 3200000
    s_mov_b32 s19, 0x20000
    v_mov_b32 v74, 0xbfb8aa3b
    v_add_u32 v75, 73728, v64
    s_waitcnt vmcnt(5)
    v_lshlrev_b32 v72, 16, v112
    v_and_b32 v73, 0xffff0000, v112
    v_mul_f32 v72, v74, v72
    v_mul_f32 v73, v74, v73
    v_cvt_pk_bf16_f32 v112, v72, v73
    v_lshlrev_b32 v72, 16, v113
    v_and_b32 v73, 0xffff0000, v113
    v_mul_f32 v72, v74, v72
    v_mul_f32 v73, v74, v73
    v_cvt_pk_bf16_f32 v113, v72, v73
    v_lshlrev_b32 v72, 16, v114
    v_and_b32 v73, 0xffff0000, v114
    v_mul_f32 v72, v74, v72
    v_mul_f32 v73, v74, v73
    v_cvt_pk_bf16_f32 v114, v72, v73
    v_lshlrev_b32 v72, 16, v115
    v_and_b32 v73, 0xffff0000, v115
    v_mul_f32 v72, v74, v72
    v_mul_f32 v73, v74, v73
    v_cvt_pk_bf16_f32 v115, v72, v73
    ds_write_b128 v75, v[112:115]
    v_lshrrev_b32 v13, 2, v0
    v_and_b32 v14, 3, v0
    v_add_u32 v29, s24, v13
    v_lshlrev_b32 v29, 7, v29
    v_lshl_add_u32 v29, v14, 4, v29
    v_mul_u32_u24 v28, 528, v13
    v_lshl_add_u32 v28, v14, 7, v28
    v_add_u32 v28, 108544, v28
    v_lshrrev_b32 v15, 1, v14
    v_lshl_add_u32 v28, v15, 6, v28
    v_and_b32 v15, 7, v13
    v_lshlrev_b32 v14, 1, v14
    v_xor_b32 v14, v14, v15
    v_lshlrev_b32 v14, 4, v14
    v_lshl_add_u32 v30, v13, 8, v14
    v_add_u32 v30, 128000, v30
    v_xor_b32 v31, 16, v30
    v_lshl_add_u32 v8, v1, 1, s24
    v_add_u32 v9, 1, v8
    v_and_b32 v8, 127, v8
    v_and_b32 v9, 127, v9
    v_lshlrev_b32 v8, 2, v8
    v_lshlrev_b32 v9, 2, v9
    s_add_u32 s39, s25, 7
    v_lshlrev_b32 v10, 1, v1
    v_add_u32 v11, 1, v10
    v_cmp_gt_u32 vcc, s39, v10
    v_cmp_gt_u32 s[76:77], s39, v11
    v_lshrrev_b32 v12, 2, v0
    v_cndmask_b32 v10, 0, 16, vcc
    v_cndmask_b32 v11, 0, 16, s[76:77]
    v_cmp_gt_u32 vcc, s39, v12
    v_cmp_gt_u32 s[76:77], s25, v12
    v_add_u32 v13, s24, v12
    v_cndmask_b32 v14, 0, 16, vcc
    v_and_b32 v13, 127, v13
    v_lshlrev_b32 v13, 2, v13
    v_mul_u32_u24 v15, 2162824, v12
    v_mov_b32 v82, 0x40000000
    v_cndmask_b32 v15, v82, v15, s[76:77]
    s_mul_i32 s39, s26, 640
    v_add_u32 v82, s39, v1
    s_mov_b32 s42, 32656
    v_lshl_add_u32 v83, v82, 3, s42
    v_lshlrev_b32 v82, 16, v82
    s_and_b32 s41, s2, 31
    s_mul_i32 s41, s41, 782
    s_mul_i32 s40, s26, 16
    s_add_u32 s41, s41, s40
    v_add_lshl_u32 v255, v1, s41, 7
    v_cmp_gt_u32 vcc, 16, v1
    v_mov_b32 v70, -16
    s_nop 0
    v_cndmask_b32 v255, v70, v255, vcc
    v_and_b32 v67, 15, v1
    v_mul_u32_u24 v67, 12, v67
    v_cmp_gt_u32 vcc, s28, v67
    v_add_u32 v66, s27, v67
    v_lshrrev_b32 v68, 4, v0
    s_mov_b32 s39, 301056
    v_mul_u32_u24 v68, s39, v68
    v_add3_u32 v68, v68, v66, -1
    v_mov_b32 v69, 0xffff
    v_cndmask_b32 v66, v69, v66, vcc
    v_mov_b32 v71, 192
    s_mov_b32 s38, 0x40000
    v_mov_b32 v195, 0x100000
    v_mov_b32 v199, 0x100000
    v_mov_b32 v203, 0x100000
    v_mov_b32 v207, 0x100000
    v_mov_b32 v211, 0x100000
    v_mov_b32 v215, 0x100000
    v_mov_b32 v219, 0x100000
    v_mov_b32 v223, 0x100000
    v_mov_b32 v227, 0x100000
    v_mov_b32 v231, 0x100000
    s_mov_b64 s[44:45], 0
    s_mov_b64 s[46:47], 0
    s_mov_b64 s[48:49], 0
    s_mov_b64 s[50:51], 0
    s_mov_b64 s[52:53], 0
    s_mov_b64 s[54:55], 0
    s_mov_b64 s[56:57], 0
    s_mov_b64 s[58:59], 0
    v_lshrrev_b32 v64, 4, v0
    v_and_b32 v65, 7, v0
    v_lshl_add_u32 v64, v64, 3, v65
    v_lshlrev_b32 v64, 6, v64
    s_lshr_b32 s31, s2, 4
    s_lshl_b32 s31, s31, 14
    s_and_b32 s40, s2, 15
    s_lshl_b32 s40, s40, 2
    s_add_u32 s31, s31, s40
    s_waitcnt vmcnt(0)
P1_RDY:
    s_lshl_b32 s40, s2, 6
    s_waitcnt lgkmcnt(0)
    s_barrier
    s_mov_b64 exec, s[80:81]
    buffer_store_dwordx4 v[244:247], v248, s[12:15], s40 offen sc1
    s_mov_b64 exec, -1
    v_cmp_gt_u32 s[36:37], s25, v254
    s_mov_b32 m0, s34
    s_nop 0
    buffer_load_dwordx4 v56, s[4:7], 0 offen offset:0 lds
    buffer_load_dwordx4 v57, s[4:7], 0 offen offset:1024 lds
    buffer_load_dwordx4 v58, s[4:7], 0 offen offset:2048 lds
    buffer_load_dwordx4 v59, s[4:7], 0 offen offset:3072 lds
    ds_read_b64_tr_b16 v[128:129], v251 offset:16384
    ds_read_b64_tr_b16 v[130:131], v251 offset:16896
    ds_read_b64_tr_b16 v[132:133], v251 offset:18432
    ds_read_b64_tr_b16 v[134:135], v251 offset:18944
    ds_read_b64_tr_b16 v[136:137], v251 offset:20480
    ds_read_b64_tr_b16 v[138:139], v251 offset:20992
    ds_read_b64_tr_b16 v[140:141], v251 offset:22528
    ds_read_b64_tr_b16 v[142:143], v251 offset:23040
    ds_read_b64_tr_b16 v[144:145], v251 offset:24576
    ds_read_b64_tr_b16 v[146:147], v251 offset:25088
    ds_read_b64_tr_b16 v[148:149], v251 offset:26624
    ds_read_b64_tr_b16 v[150:151], v251 offset:27136
    ds_read_b64_tr_b16 v[152:153], v251 offset:28672
    ds_read_b64_tr_b16 v[154:155], v251 offset:29184
    ds_read_b64_tr_b16 v[156:157], v251 offset:30720
    ds_read_b64_tr_b16 v[158:159], v251 offset:31232
    ds_read_b64_tr_b16 v[160:161], v249 offset:8192
    ds_read_b64_tr_b16 v[162:163], v249 offset:8704
    ds_read_b64_tr_b16 v[164:165], v249 offset:10240
    ds_read_b64_tr_b16 v[166:167], v249 offset:10752
    ds_read_b64_tr_b16 v[168:169], v249 offset:12288
    ds_read_b64_tr_b16 v[170:171], v249 offset:12800
    ds_read_b64_tr_b16 v[172:173], v249 offset:14336
    ds_read_b64_tr_b16 v[174:175], v249 offset:14848
    ds_read_b64_tr_b16 v[176:177], v250 offset:8192
    ds_read_b64_tr_b16 v[178:179], v250 offset:8704
    ds_read_b64_tr_b16 v[180:181], v250 offset:10240
    ds_read_b64_tr_b16 v[182:183], v250 offset:10752
    ds_read_b64_tr_b16 v[184:185], v250 offset:12288
    ds_read_b64_tr_b16 v[186:187], v250 offset:12800
    ds_read_b64_tr_b16 v[188:189], v250 offset:14336
    ds_read_b64_tr_b16 v[190:191], v250 offset:14848
    ds_read_b64_tr_b16 v[104:105], v253 offset:0
    ds_read_b64_tr_b16 v[108:109], v253 offset:64
    s_and_b32 s40, s26, 1
    s_lshl_b32 s40, s40, 3
    s_movk_i32 s41, 112
    v_cmp_gt_u32 s[78:79], s41, v254
    v_and_b32 v80, 7, v1
    v_xor_b32 v80, v80, v81
    v_or_b32 v80, s40, v80
    v_lshlrev_b32 v254, 8, v254
    v_add_u32 v254, 128000, v254
    v_xor_b32 v32, 0, v80
    v_lshl_add_u32 v32, v32, 4, v254
    v_xor_b32 v33, 2, v80
    v_lshl_add_u32 v33, v33, 4, v254
    v_xor_b32 v34, 4, v80
    v_lshl_add_u32 v34, v34, 4, v254
    v_xor_b32 v35, 6, v80
    v_lshl_add_u32 v35, v35, 4, v254
    v_mov_b32 v80, 0xbfb8aa3b
    s_waitcnt vmcnt(0)
    ds_read_b128 v[40:43], v24
    ds_read_b128 v[44:47], v25
    ds_read_b128 v[48:51], v26
    ds_read_b128 v[52:55], v27
    s_waitcnt lgkmcnt(0)
    v_mfma_f32_32x32x16_bf16 v[84:99], v[128:131], v[40:43], 0
    v_mfma_f32_32x32x16_bf16 v[84:99], v[132:135], v[44:47], v[84:99]
    v_mfma_f32_32x32x16_bf16 v[84:99], v[136:139], v[48:51], v[84:99]
    v_mfma_f32_32x32x16_bf16 v[84:99], v[140:143], v[52:55], v[84:99]
    v_mfma_f32_32x32x16_bf16 v[112:127], v[144:147], v[40:43], 0
    v_mfma_f32_32x32x16_bf16 v[112:127], v[148:151], v[44:47], v[112:127]
    v_mfma_f32_32x32x16_bf16 v[112:127], v[152:155], v[48:51], v[112:127]
    v_mfma_f32_32x32x16_bf16 v[112:127], v[156:159], v[52:55], v[112:127]
    s_cmp_ge_u32 s26, 4
    s_cbranch_scc0 K2_TY0
    buffer_load_dword v65, v64, s[12:15], s31 offen sc1
K2_TY0:
    ds_read_b64_tr_b16 v[128:129], v249 offset:0
    ds_read_b64_tr_b16 v[130:131], v249 offset:512
    ds_read_b64_tr_b16 v[132:133], v249 offset:2048
    ds_read_b64_tr_b16 v[134:135], v249 offset:2560
    ds_read_b64_tr_b16 v[136:137], v249 offset:4096
    ds_read_b64_tr_b16 v[138:139], v249 offset:4608
    ds_read_b64_tr_b16 v[140:141], v249 offset:6144
    ds_read_b64_tr_b16 v[142:143], v249 offset:6656
    ds_read_b64_tr_b16 v[144:145], v250 offset:0
    ds_read_b64_tr_b16 v[146:147], v250 offset:512
    ds_read_b64_tr_b16 v[148:149], v250 offset:2048
    ds_read_b64_tr_b16 v[150:151], v250 offset:2560
    ds_read_b64_tr_b16 v[152:153], v250 offset:4096
    ds_read_b64_tr_b16 v[154:155], v250 offset:4608
    ds_read_b64_tr_b16 v[156:157], v250 offset:6144
    ds_read_b64_tr_b16 v[158:159], v250 offset:6656
    v_mul_f32 v84, v80, v84
    v_mul_f32 v85, v80, v85
    v_mul_f32 v86, v80, v86
    v_mul_f32 v87, v80, v87
    v_mul_f32 v88, v80, v88
    v_mul_f32 v89, v80, v89
    v_mul_f32 v90, v80, v90
    v_mul_f32 v91, v80, v91
    v_mul_f32 v92, v80, v92
    v_mul_f32 v93, v80, v93
    v_mul_f32 v94, v80, v94
    v_mul_f32 v95, v80, v95
    v_mul_f32 v96, v80, v96
    v_mul_f32 v97, v80, v97
    v_mul_f32 v98, v80, v98
    v_mul_f32 v99, v80, v99
    v_cvt_pk_bf16_f32 v72, v84, v85
    v_cvt_pk_bf16_f32 v73, v86, v87
    v_cvt_pk_bf16_f32 v74, v88, v89
    v_cvt_pk_bf16_f32 v75, v90, v91
    v_cvt_pk_bf16_f32 v76, v92, v93
    v_cvt_pk_bf16_f32 v77, v94, v95
    v_cvt_pk_bf16_f32 v78, v96, v97
    v_cvt_pk_bf16_f32 v79, v98, v99
    s_mov_b64 exec, s[36:37]
    ds_write_b64 v252, v[72:73] offset:19328
    ds_write_b64 v252, v[74:75] offset:19344
    ds_write_b64 v252, v[76:77] offset:19360
    ds_write_b64 v252, v[78:79] offset:19376
    s_mov_b64 exec, s[78:79]
    ds_write_b128 v32, v[112:115]
    ds_write_b128 v33, v[116:119]
    ds_write_b128 v34, v[120:123]
    ds_write_b128 v35, v[124:127]
    s_mov_b64 exec, -1
    s_cbranch_scc1 K2_ROUND
    buffer_load_dword v65, v64, s[12:15], s31 offen sc1
K2_ROUND:
    v_mov_b32 v112, 0
    v_mov_b32 v113, 0
    v_mov_b32 v114, 0
    v_mov_b32 v115, 0
    v_mov_b32 v116, 0
    v_mov_b32 v117, 0
    v_mov_b32 v118, 0
    v_mov_b32 v119, 0
    v_mov_b32 v120, 0
    v_mov_b32 v121, 0
K2_POLL:
    s_waitcnt vmcnt(0)
    v_cmp_eq_u32 s[76:77], 0, v65
    v_mov_b32_dpp v240, v65 row_newbcast:0 row_mask:0xf bank_mask:0xf
    v_mov_b32_dpp v241, v65 row_newbcast:1 row_mask:0xf bank_mask:0xf
    v_mov_b32_dpp v242, v65 row_newbcast:2 row_mask:0xf bank_mask:0xf
    v_mov_b32_dpp v243, v65 row_newbcast:3 row_mask:0xf bank_mask:0xf
    v_mov_b32_dpp v244, v65 row_newbcast:4 row_mask:0xf bank_mask:0xf
    v_mov_b32_dpp v245, v65 row_newbcast:5 row_mask:0xf bank_mask:0xf
    v_mov_b32_dpp v246, v65 row_newbcast:6 row_mask:0xf bank_mask:0xf
    v_mov_b32_dpp v247, v65 row_newbcast:7 row_mask:0xf bank_mask:0xf
    s_mov_b32 s40, 524288
    v_mov_b32 v72, 0
    v_mov_b32 v73, 0
    v_cmp_lt_u32_sdwa vcc, v66, v240 src0_sel:DWORD src1_sel:WORD_1
    v_add_u32_sdwa v232, v68, v240 dst_sel:DWORD dst_unused:UNUSED_PAD src0_sel:DWORD src1_sel:WORD_0
    s_andn2_b64 exec, vcc, s[44:45]
    buffer_load_dwordx3 v[192:194], v232, s[12:15], s40 offen sc1
    s_mov_b64 s[44:45], vcc
    s_mov_b64 exec, -1
    s_add_u32 s40, s40, 37632
    v_sub_u32_sdwa v69, v240, v71 clamp dst_sel:DWORD dst_unused:UNUSED_PAD src0_sel:WORD_1 src1_sel:DWORD
    v_add_u32 v74, v67, v72
    s_mov_b32 s41, 192
    v_cmp_lt_u32 vcc, v74, v69
    v_add3_u32 v75, v232, v72, s41
    v_sub_u32 v72, v72, v69
    v_cndmask_b32 v73, v73, v75, vcc
    v_cmp_lt_u32_sdwa vcc, v66, v241 src0_sel:DWORD src1_sel:WORD_1
    v_add_u32_sdwa v233, v68, v241 dst_sel:DWORD dst_unused:UNUSED_PAD src0_sel:DWORD src1_sel:WORD_0
    s_andn2_b64 exec, vcc, s[46:47]
    buffer_load_dwordx3 v[196:198], v233, s[12:15], s40 offen sc1
    s_mov_b64 s[46:47], vcc
    s_mov_b64 exec, -1
    s_add_u32 s40, s40, 37632
    v_sub_u32_sdwa v69, v241, v71 clamp dst_sel:DWORD dst_unused:UNUSED_PAD src0_sel:WORD_1 src1_sel:DWORD
    v_add_u32 v74, v67, v72
    s_mov_b32 s41, 37824
    v_cmp_lt_u32 vcc, v74, v69
    v_add3_u32 v75, v233, v72, s41
    v_sub_u32 v72, v72, v69
    v_cndmask_b32 v73, v73, v75, vcc
    v_cmp_lt_u32_sdwa vcc, v66, v242 src0_sel:DWORD src1_sel:WORD_1
    v_add_u32_sdwa v234, v68, v242 dst_sel:DWORD dst_unused:UNUSED_PAD src0_sel:DWORD src1_sel:WORD_0
    s_andn2_b64 exec, vcc, s[48:49]
    buffer_load_dwordx3 v[200:202], v234, s[12:15], s40 offen sc1
    s_mov_b64 s[48:49], vcc
    s_mov_b64 exec, -1
    s_add_u32 s40, s40, 37632
    v_sub_u32_sdwa v69, v242, v71 clamp dst_sel:DWORD dst_unused:UNUSED_PAD src0_sel:WORD_1 src1_sel:DWORD
    v_add_u32 v74, v67, v72
    s_mov_b32 s41, 75456
    v_cmp_lt_u32 vcc, v74, v69
    v_add3_u32 v75, v234, v72, s41
    v_sub_u32 v72, v72, v69
    v_cndmask_b32 v73, v73, v75, vcc
    v_cmp_lt_u32_sdwa vcc, v66, v243 src0_sel:DWORD src1_sel:WORD_1
    v_add_u32_sdwa v235, v68, v243 dst_sel:DWORD dst_unused:UNUSED_PAD src0_sel:DWORD src1_sel:WORD_0
    s_andn2_b64 exec, vcc, s[50:51]
    buffer_load_dwordx3 v[204:206], v235, s[12:15], s40 offen sc1
    s_mov_b64 s[50:51], vcc
    s_mov_b64 exec, -1
    s_add_u32 s40, s40, 37632
    v_sub_u32_sdwa v69, v243, v71 clamp dst_sel:DWORD dst_unused:UNUSED_PAD src0_sel:WORD_1 src1_sel:DWORD
    v_add_u32 v74, v67, v72
    s_mov_b32 s41, 113088
    v_cmp_lt_u32 vcc, v74, v69
    v_add3_u32 v75, v235, v72, s41
    v_sub_u32 v72, v72, v69
    v_cndmask_b32 v73, v73, v75, vcc
    v_cmp_lt_u32_sdwa vcc, v66, v244 src0_sel:DWORD src1_sel:WORD_1
    v_add_u32_sdwa v236, v68, v244 dst_sel:DWORD dst_unused:UNUSED_PAD src0_sel:DWORD src1_sel:WORD_0
    s_andn2_b64 exec, vcc, s[52:53]
    buffer_load_dwordx3 v[208:210], v236, s[12:15], s40 offen sc1
    s_mov_b64 s[52:53], vcc
    s_mov_b64 exec, -1
    s_add_u32 s40, s40, 37632
    v_sub_u32_sdwa v69, v244, v71 clamp dst_sel:DWORD dst_unused:UNUSED_PAD src0_sel:WORD_1 src1_sel:DWORD
    v_add_u32 v74, v67, v72
    s_mov_b32 s41, 150720
    v_cmp_lt_u32 vcc, v74, v69
    v_add3_u32 v75, v236, v72, s41
    v_sub_u32 v72, v72, v69
    v_cndmask_b32 v73, v73, v75, vcc
    v_cmp_lt_u32_sdwa vcc, v66, v245 src0_sel:DWORD src1_sel:WORD_1
    v_add_u32_sdwa v237, v68, v245 dst_sel:DWORD dst_unused:UNUSED_PAD src0_sel:DWORD src1_sel:WORD_0
    s_andn2_b64 exec, vcc, s[54:55]
    buffer_load_dwordx3 v[212:214], v237, s[12:15], s40 offen sc1
    s_mov_b64 s[54:55], vcc
    s_mov_b64 exec, -1
    s_add_u32 s40, s40, 37632
    v_sub_u32_sdwa v69, v245, v71 clamp dst_sel:DWORD dst_unused:UNUSED_PAD src0_sel:WORD_1 src1_sel:DWORD
    v_add_u32 v74, v67, v72
    s_mov_b32 s41, 188352
    v_cmp_lt_u32 vcc, v74, v69
    v_add3_u32 v75, v237, v72, s41
    v_sub_u32 v72, v72, v69
    v_cndmask_b32 v73, v73, v75, vcc
    v_cmp_lt_u32_sdwa vcc, v66, v246 src0_sel:DWORD src1_sel:WORD_1
    v_add_u32_sdwa v238, v68, v246 dst_sel:DWORD dst_unused:UNUSED_PAD src0_sel:DWORD src1_sel:WORD_0
    s_andn2_b64 exec, vcc, s[56:57]
    buffer_load_dwordx3 v[216:218], v238, s[12:15], s40 offen sc1
    s_mov_b64 s[56:57], vcc
    s_mov_b64 exec, -1
    s_add_u32 s40, s40, 37632
    v_sub_u32_sdwa v69, v246, v71 clamp dst_sel:DWORD dst_unused:UNUSED_PAD src0_sel:WORD_1 src1_sel:DWORD
    v_add_u32 v74, v67, v72
    s_mov_b32 s41, 225984
    v_cmp_lt_u32 vcc, v74, v69
    v_add3_u32 v75, v238, v72, s41
    v_sub_u32 v72, v72, v69
    v_cndmask_b32 v73, v73, v75, vcc
    v_cmp_lt_u32_sdwa vcc, v66, v247 src0_sel:DWORD src1_sel:WORD_1
    v_add_u32_sdwa v239, v68, v247 dst_sel:DWORD dst_unused:UNUSED_PAD src0_sel:DWORD src1_sel:WORD_0
    s_andn2_b64 exec, vcc, s[58:59]
    buffer_load_dwordx3 v[220:222], v239, s[12:15], s40 offen sc1
    s_mov_b64 s[58:59], vcc
    s_mov_b64 exec, -1
    v_sub_u32_sdwa v69, v247, v71 clamp dst_sel:DWORD dst_unused:UNUSED_PAD src0_sel:WORD_1 src1_sel:DWORD
    v_add_u32 v74, v67, v72
    s_mov_b32 s41, 263616
    v_cmp_lt_u32 vcc, v74, v69
    v_add3_u32 v75, v239, v72, s41
    v_sub_u32 v72, v72, v69
    v_cndmask_b32 v73, v73, v75, vcc
    s_cmp_eq_u64 s[76:77], 0
    s_cbranch_scc1 K2_GO
    s_sub_u32 s38, s38, 1
    s_cbranch_scc1 K2_END
    s_sleep 10
    buffer_load_dword v65, v64, s[12:15], s31 offen sc1
    s_branch K2_POLL
K2_GO:
    v_add_u32 v74, v67, v72
    v_cmp_gt_i32 s[60:61], 0, v74
    s_mov_b32 s38, 524288
    s_cmp_eq_u32 s28, 384
    s_cselect_b64 s[60:61], s[60:61], 0
    s_mov_b64 exec, s[60:61]
    buffer_load_dwordx3 v[224:226], v73, s[12:15], s38 offen sc1
    s_mov_b64 exec, -1
    v_add_u32 v75, 192, v74
    v_add_u32 v69, 384, v72
    v_cmp_gt_i32 s[62:63], 0, v75
    v_cmp_gt_i32 s[76:77], 0, v69
    v_max3_u32 v69, v240, v241, v242
    v_max3_u32 v70, v243, v244, v245
    v_max3_u32 v69, v69, v246, v247
    v_max_u32 v69, v69, v70
    s_add_u32 s40, s27, s28
    s_lshl_b32 s40, s40, 16
    s_or_b32 s40, s40, 0xffff
    v_cmp_lt_u32 vcc, s40, v69
    s_cmp_eq_u32 s28, 384
    s_cselect_b64 s[62:63], s[62:63], 0
    s_cselect_b64 s[76:77], s[76:77], vcc
    s_cmp_lg_u64 s[62:63], 0
    s_cbranch_scc1 K2_OVF2
K2_OVFD:
    v_mov_b32 v66, 4
    v_mov_b32 v67, 0
    s_mov_b64 exec, s[76:77]
    ds_write_b32 v67, v66 offset:512
    s_mov_b64 exec, -1
    s_mov_b32 s39, 0xffff
    s_mov_b64 exec, s[44:45]
    s_waitcnt vmcnt(8)
    v_lshrrev_b32 v112, 16, v194
    ds_add_rtn_u32 v195, v112, v66 offset:0
    ds_write_b64 v83, v[192:193] offset:0
    v_and_or_b32 v194, v194, s39, v82
    s_mov_b64 exec, s[46:47]
    s_waitcnt vmcnt(7)
    v_lshrrev_b32 v113, 16, v198
    ds_add_rtn_u32 v199, v113, v66 offset:0
    ds_write_b64 v83, v[196:197] offset:512
    v_and_or_b32 v198, v198, s39, v82
    v_add_u32 v198, 0x400000, v198
    s_mov_b64 exec, s[48:49]
    s_waitcnt vmcnt(6)
    v_lshrrev_b32 v114, 16, v202
    ds_add_rtn_u32 v203, v114, v66 offset:0
    ds_write_b64 v83, v[200:201] offset:1024
    v_and_or_b32 v202, v202, s39, v82
    v_add_u32 v202, 0x800000, v202
    s_mov_b64 exec, s[50:51]
    s_waitcnt vmcnt(5)
    v_lshrrev_b32 v115, 16, v206
    ds_add_rtn_u32 v207, v115, v66 offset:0
    ds_write_b64 v83, v[204:205] offset:1536
    v_and_or_b32 v206, v206, s39, v82
    v_add_u32 v206, 0xc00000, v206
    s_mov_b64 exec, s[52:53]
    s_waitcnt vmcnt(4)
    v_lshrrev_b32 v116, 16, v210
    ds_add_rtn_u32 v211, v116, v66 offset:0
    ds_write_b64 v83, v[208:209] offset:2048
    v_and_or_b32 v210, v210, s39, v82
    v_add_u32 v210, 0x1000000, v210
    s_mov_b64 exec, s[54:55]
    s_waitcnt vmcnt(3)
    v_lshrrev_b32 v117, 16, v214
    ds_add_rtn_u32 v215, v117, v66 offset:0
    ds_write_b64 v83, v[212:213] offset:2560
    v_and_or_b32 v214, v214, s39, v82
    v_add_u32 v214, 0x1400000, v214
    s_mov_b64 exec, s[56:57]
    s_waitcnt vmcnt(2)
    v_lshrrev_b32 v118, 16, v218
    ds_add_rtn_u32 v219, v118, v66 offset:0
    ds_write_b64 v83, v[216:217] offset:3072
    v_and_or_b32 v218, v218, s39, v82
    v_add_u32 v218, 0x1800000, v218
    s_mov_b64 exec, s[58:59]
    s_waitcnt vmcnt(1)
    v_lshrrev_b32 v119, 16, v222
    ds_add_rtn_u32 v223, v119, v66 offset:0
    ds_write_b64 v83, v[220:221] offset:3584
    v_and_or_b32 v222, v222, s39, v82
    v_add_u32 v222, 0x1c00000, v222
    s_mov_b64 exec, s[60:61]
    s_waitcnt vmcnt(0)
    v_lshrrev_b32 v120, 16, v226
    ds_add_rtn_u32 v227, v120, v66 offset:0
    ds_write_b64 v83, v[224:225] offset:4096
    v_and_or_b32 v226, v226, s39, v82
    v_add_u32 v226, 0x2000000, v226
    s_mov_b64 exec, s[62:63]
    v_lshrrev_b32 v121, 16, v230
    ds_add_rtn_u32 v231, v121, v66 offset:0
    ds_write_b64 v83, v[228:229] offset:4608
    v_and_or_b32 v230, v230, s39, v82
    v_add_u32 v230, 0x2400000, v230
    s_mov_b64 exec, -1
    s_waitcnt lgkmcnt(0)
    s_barrier
    ds_read_b32 v64, v8 offset:0
    ds_read_b32 v65, v9 offset:0
    ds_read_b32 v68, v67 offset:512
    buffer_load_dwordx4 v[32:35], v29, s[8:11], 0 offen
    buffer_load_dwordx4 v[36:39], v29, s[8:11], 0 offen offset:64
    buffer_load_dword v255, v255, s[8:11], 0 offen
    s_waitcnt lgkmcnt(1)
    s_cmp_eq_u32 s29, 0
    s_cbranch_scc1 K2_NOU
    ds_read_b128 v[40:43], v30 offset:0
    ds_read_b128 v[44:47], v31 offset:0
    ds_read_b128 v[48:51], v30 offset:128
    ds_read_b128 v[52:55], v31 offset:128
K2_NOU:
    v_add_u32 v69, 15, v64
    v_add_u32 v70, 15, v65
    v_and_b32 v69, -16, v69
    v_and_b32 v70, -16, v70
    v_max_u32 v69, v69, v10
    v_max_u32 v70, v70, v11
    v_add_u32 v71, v69, v70
    v_mov_b32 v72, v71
    s_nop 1
    v_add_u32_dpp v72, v72, v72 row_shr:1 row_mask:0xf bank_mask:0xf
    s_nop 1
    v_add_u32_dpp v72, v72, v72 row_shr:2 row_mask:0xf bank_mask:0xf
    s_nop 1
    v_add_u32_dpp v72, v72, v72 row_shr:4 row_mask:0xf bank_mask:0xf
    s_nop 1
    v_add_u32_dpp v72, v72, v72 row_shr:8 row_mask:0xf bank_mask:0xf
    s_nop 1
    v_add_u32_dpp v72, v72, v72 row_bcast:15 row_mask:0xa bank_mask:0xf
    s_nop 1
    v_add_u32_dpp v72, v72, v72 row_bcast:31 row_mask:0xc bank_mask:0xf
    v_sub_u32 v73, v72, v71
    v_add_u32 v74, v73, v69
    v_readlane_b32 s31, v72, 63
    v_lshl_or_b32 v64, v64, 16, v73
    v_lshl_or_b32 v65, v65, 16, v74
    ds_write_b32 v8, v64 offset:528
    ds_write_b32 v9, v65 offset:528
    v_max_u32 v69, v69, v70
    s_lshr_b32 s32, s31, 7
    ds_read_b32 v64, v13 offset:528
    ds_read_u16 v112, v112 offset:528
    ds_read_u16 v113, v113 offset:528
    ds_read_u16 v114, v114 offset:528
    ds_read_u16 v115, v115 offset:528
    ds_read_u16 v116, v116 offset:528
    ds_read_u16 v117, v117 offset:528
    ds_read_u16 v118, v118 offset:528
    ds_read_u16 v119, v119 offset:528
    ds_read_u16 v120, v120 offset:528
    ds_read_u16 v121, v121 offset:528
    s_lshr_b32 s39, s32, 3
    s_and_b32 s40, s32, 7
    s_lshl_b32 s41, s39, 4
    s_add_u32 s38, s41, 16
    v_cmp_lt_u32 vcc, s38, v69
    s_add_u32 s38, s38, s41
    v_cmp_lt_u32 s[76:77], s38, v69
    s_mul_i32 s34, s39, s26
    s_min_u32 s41, s40, s26
    s_add_u32 s34, s34, s41
    s_lshl_b32 s34, s34, 3
    s_cmp_lt_u32 s26, s40
    s_addc_u32 s33, s39, 0
    s_cmp_lg_u64 vcc, 0
    s_cselect_b32 s37, 1, 0
    s_cmp_lg_u64 s[76:77], 0
    s_cselect_b32 s37, 2, s37
    v_bfe_u32 v66, v1, 3, 1
    v_lshrrev_b32 v69, 4, v1
    v_lshl_add_u32 v66, v66, 2, v69
    v_mul_u32_u24 v66, s33, v66
    v_add_lshl_u32 v4, v66, s34, 4
    s_mov_b32 m0, s35
    s_mov_b32 s43, 0x40000000
    s_waitcnt lgkmcnt(13)
    v_readfirstlane_b32 s36, v68
    s_cmp_gt_u32 s31, 14336
    s_cselect_b32 s39, 1, s36
    s_cmp_eq_u32 s28, 384
    s_cselect_b32 s39, s39, 0
    s_cmp_lg_u32 s39, 0
    s_cbranch_scc1 K2_FAIL
    s_waitcnt lgkmcnt(5)
    v_add_u32 v112, v112, v195
    ds_write_b32 v112, v194 offset:1280
    v_add_u32 v113, v113, v199
    ds_write_b32 v113, v198 offset:1280
    v_add_u32 v114, v114, v203
    ds_write_b32 v114, v202 offset:1280
    v_add_u32 v115, v115, v207
    ds_write_b32 v115, v206 offset:1280
    v_add_u32 v116, v116, v211
    ds_write_b32 v116, v210 offset:1280
    s_waitcnt lgkmcnt(5)
    v_add_u32 v117, v117, v215
    ds_write_b32 v117, v214 offset:1280
    v_add_u32 v118, v118, v219
    ds_write_b32 v118, v218 offset:1280
    v_add_u32 v119, v119, v223
    ds_write_b32 v119, v222 offset:1280
    v_add_u32 v120, v120, v227
    ds_write_b32 v120, v226 offset:1280
    v_add_u32 v121, v121, v231
    ds_write_b32 v121, v230 offset:1280
    v_and_b32 v65, 3, v0
    v_mov_b32 v70, 0x7f007f00
    v_lshrrev_b32 v68, 16, v64
    v_and_b32 v64, 0xffff, v64
    v_add_u32 v74, 15, v68
    v_and_b32 v74, -16, v74
    v_max_u32 v74, v74, v14
    v_lshl_add_u32 v68, v65, 2, v68
    v_cmp_lt_u32 vcc, v68, v74
    v_add_u32 v68, v68, v64
    s_mov_b64 exec, vcc
    ds_write_b32 v68, v70 offset:1280
    s_mov_b64 exec, -1
    s_waitcnt lgkmcnt(0)
    s_barrier
    ds_read_b128 v[56:59], v4 offset:1280
    v_add_u32 v4, 16, v4
    v_lshrrev_b32 v69, 4, v74
    v_lshrrev_b32 v64, 4, v64
    v_add_lshl_u32 v68, v64, v65, 2
    v_add_u32 v70, -1, v69
    v_or_b32 v71, 0x80000000, v15
    s_cmp_ge_u32 s26, 4
    s_cbranch_scc1 K2_ORD_B
    s_waitcnt lgkmcnt(0)
    v_mad_u32_u16 v56, v56, s30, v60
    v_mad_u32_u16 v57, v57, s30, v61
    v_mad_u32_u16 v58, v58, s30, v62
    v_mad_u32_u16 v59, v59, s30, v63
    buffer_load_dwordx4 v56, s[4:7], 0 offen offset:0 lds
    buffer_load_dwordx4 v57, s[4:7], 0 offen offset:1024 lds
    buffer_load_dwordx4 v58, s[4:7], 0 offen offset:2048 lds
    buffer_load_dwordx4 v59, s[4:7], 0 offen offset:3072 lds
    ds_read_b128 v[56:59], v4 offset:1280
    v_add_u32 v4, 16, v4
    s_mov_b32 s40, 109056
    v_mad_u32_u16 v72, v15, 16, s40 op_sel:[1,0,0,0]
    v_mov_b32 v73, 0x100000
    v_mov_b32 v75, 160288
    ds_write2_b32 v72, v75, v73 offset0:0 offset1:1
    s_cmp_lg_u32 s29, 0
    s_cselect_b32 s80, 0x4d8637bd, 0
    v_lshl_add_u32 v72, v1, 3, v75
    v_mov_b32 v73, s80
    ds_write2_b32 v72, v73, v67 offset0:0 offset1:1
    v_cmp_lt_u32 vcc, v65, v69
    v_cmp_eq_u32 s[76:77], v65, v70
    s_and_b64 exec, exec, vcc
    v_add_u32 v65, 4, v65
    v_cndmask_b32 v72, v71, v15, s[76:77]
    ds_write_b32 v68, v72 offset:15680
    v_cmp_lt_u32 vcc, v65, v69
    v_cmp_eq_u32 s[76:77], v65, v70
    s_and_b64 exec, exec, vcc
    v_add_u32 v65, 4, v65
    v_cndmask_b32 v72, v71, v15, s[76:77]
    ds_write_b32 v68, v72 offset:15696
    v_cmp_lt_u32 vcc, v65, v69
    v_cmp_eq_u32 s[76:77], v65, v70
    s_and_b64 exec, exec, vcc
    v_add_u32 v65, 4, v65
    v_cndmask_b32 v72, v71, v15, s[76:77]
    ds_write_b32 v68, v72 offset:15712
K2_QMa:
    v_cmp_lt_u32 vcc, v65, v69
    v_cmp_eq_u32 s[76:77], v65, v70
    s_and_b64 exec, exec, vcc
    s_cbranch_execz K2_QMDa
    v_add_u32 v65, 4, v65
    v_cndmask_b32 v72, v71, v15, s[76:77]
    ds_write_b32 v68, v72 offset:15728
    v_add_u32 v68, 16, v68
    s_branch K2_QMa
K2_QMDa:
    s_mov_b64 exec, -1
    v_lshrrev_b32 v66, 5, v1
    v_bfe_u32 v69, v1, 2, 2
    v_lshl_add_u32 v66, v66, 2, v69
    v_mul_u32_u24 v66, s33, v66
    v_add_lshl_u32 v5, v66, s34, 2
    v_bfe_u32 v8, v1, 2, 1
    v_bfe_u32 v9, v1, 3, 2
    v_lshl_add_u32 v8, v8, 2, v9
    v_mul_u32_u24 v8, s33, v8
    v_add_lshl_u32 v8, v8, s34, 2
    v_and_or_b32 v8, v1, 3, v8
    v_lshlrev_b32 v2, 2, v8
    s_waitcnt lgkmcnt(0)
    s_barrier
    s_branch K2_ORD_J
K2_ORD_B:
    s_mov_b32 s40, 109056
    v_mad_u32_u16 v72, v15, 16, s40 op_sel:[1,0,0,0]
    v_mov_b32 v73, 0x100000
    v_mov_b32 v75, 160288
    ds_write2_b32 v72, v75, v73 offset0:0 offset1:1
    s_cmp_lg_u32 s29, 0
    s_cselect_b32 s80, 0x4d8637bd, 0
    v_lshl_add_u32 v72, v1, 3, v75
    v_mov_b32 v73, s80
    ds_write2_b32 v72, v73, v67 offset0:0 offset1:1
    v_cmp_lt_u32 vcc, v65, v69
    v_cmp_eq_u32 s[76:77], v65, v70
    s_and_b64 exec, exec, vcc
    v_add_u32 v65, 4, v65
    v_cndmask_b32 v72, v71, v15, s[76:77]
    ds_write_b32 v68, v72 offset:15680
    v_cmp_lt_u32 vcc, v65, v69
    v_cmp_eq_u32 s[76:77], v65, v70
    s_and_b64 exec, exec, vcc
    v_add_u32 v65, 4, v65
    v_cndmask_b32 v72, v71, v15, s[76:77]
    ds_write_b32 v68, v72 offset:15696
    v_cmp_lt_u32 vcc, v65, v69
    v_cmp_eq_u32 s[76:77], v65, v70
    s_and_b64 exec, exec, vcc
    v_add_u32 v65, 4, v65
    v_cndmask_b32 v72, v71, v15, s[76:77]
    ds_write_b32 v68, v72 offset:15712
K2_QMb:
    v_cmp_lt_u32 vcc, v65, v69
    v_cmp_eq_u32 s[76:77], v65, v70
    s_and_b64 exec, exec, vcc
    s_cbranch_execz K2_QMDb
    v_add_u32 v65, 4, v65
    v_cndmask_b32 v72, v71, v15, s[76:77]
    ds_write_b32 v68, v72 offset:15728
    v_add_u32 v68, 16, v68
    s_branch K2_QMb
K2_QMDb:
    s_mov_b64 exec, -1
    v_lshrrev_b32 v66, 5, v1
    v_bfe_u32 v69, v1, 2, 2
    v_lshl_add_u32 v66, v66, 2, v69
    v_mul_u32_u24 v66, s33, v66
    v_add_lshl_u32 v5, v66, s34, 2
    v_bfe_u32 v8, v1, 2, 1
    v_bfe_u32 v9, v1, 3, 2
    v_lshl_add_u32 v8, v8, 2, v9
    v_mul_u32_u24 v8, s33, v8
    v_add_lshl_u32 v8, v8, s34, 2
    v_and_or_b32 v8, v1, 3, v8
    v_lshlrev_b32 v2, 2, v8
    s_waitcnt lgkmcnt(0)
    s_barrier
    v_mad_u32_u16 v56, v56, s30, v60
    v_mad_u32_u16 v57, v57, s30, v61
    v_mad_u32_u16 v58, v58, s30, v62
    v_mad_u32_u16 v59, v59, s30, v63
    buffer_load_dwordx4 v56, s[4:7], 0 offen offset:0 lds
    buffer_load_dwordx4 v57, s[4:7], 0 offen offset:1024 lds
    buffer_load_dwordx4 v58, s[4:7], 0 offen offset:2048 lds
    buffer_load_dwordx4 v59, s[4:7], 0 offen offset:3072 lds
    ds_read_b128 v[56:59], v4 offset:1280
    v_add_u32 v4, 16, v4
K2_ORD_J:
    ds_read_u16 v6, v5 offset:15680
    ds_read_u16 v3, v2 offset:1282
    ds_read_b32 v64, v5 offset:15680
    v_add_u32 v5, 4, v5
    s_cmp_eq_u32 s29, 0
    s_cbranch_scc1 K2_NOV
    s_waitcnt vmcnt(5)
    v_lshlrev_b32 v8, 16, v32
    v_and_b32 v9, 0xffff0000, v32
    v_add_f32 v40, v40, v8
    v_add_f32 v41, v41, v9
    v_lshlrev_b32 v8, 16, v33
    v_and_b32 v9, 0xffff0000, v33
    v_add_f32 v42, v42, v8
    v_add_f32 v43, v43, v9
    v_lshlrev_b32 v8, 16, v34
    v_and_b32 v9, 0xffff0000, v34
    v_add_f32 v44, v44, v8
    v_add_f32 v45, v45, v9
    v_lshlrev_b32 v8, 16, v35
    v_and_b32 v9, 0xffff0000, v35
    v_add_f32 v46, v46, v8
    v_add_f32 v47, v47, v9
    v_lshlrev_b32 v8, 16, v36
    v_and_b32 v9, 0xffff0000, v36
    v_add_f32 v48, v48, v8
    v_add_f32 v49, v49, v9
    v_lshlrev_b32 v8, 16, v37
    v_and_b32 v9, 0xffff0000, v37
    v_add_f32 v50, v50, v8
    v_add_f32 v51, v51, v9
    v_lshlrev_b32 v8, 16, v38
    v_and_b32 v9, 0xffff0000, v38
    v_add_f32 v52, v52, v8
    v_add_f32 v53, v53, v9
    v_lshlrev_b32 v8, 16, v39
    v_and_b32 v9, 0xffff0000, v39
    v_add_f32 v54, v54, v8
    v_add_f32 v55, v55, v9
K2_NOV:
    s_waitcnt lgkmcnt(0)
    v_add_u32 v6, v6, v7
    v_lshl_add_u32 v3, v3, 3, s42
    v_and_b32 v64, 0x3fffffff, v64
    ds_read_b64_tr_b16 v[106:107], v6 offset:19328
    ds_read_b64_tr_b16 v[110:111], v6 offset:19392
    ds_read_b32 v100, v2 offset:1280
    s_mov_b32 exec_lo, 0
    ds_read_b64 v[100:101], v3
    s_mov_b32 exec_lo, -1
    ds_read_u16 v6, v5 offset:15680
    ds_read_u16 v3, v2 offset:1298
    v_mov_b32 v8, 0
    v_mov_b32 v9, 0
    v_mov_b32 v10, 0
    v_mov_b32 v11, 0
    v_mov_b32 v12, 0
    v_mov_b32 v13, 0
    v_mov_b32 v14, 0
    v_mov_b32 v15, 0
    v_mov_b32 v84, 0
    v_mov_b32 v85, 0
    v_mov_b32 v86, 0
    v_mov_b32 v87, 0
    v_mov_b32 v88, 0
    v_mov_b32 v89, 0
    v_mov_b32 v90, 0
    v_mov_b32 v91, 0
    v_mov_b32 v92, 0
    v_mov_b32 v93, 0
    v_mov_b32 v94, 0
    v_mov_b32 v95, 0
    v_mov_b32 v96, 0
    v_mov_b32 v97, 0
    v_mov_b32 v98, 0
    v_mov_b32 v99, 0
    v_mov_b32 v76, 0
    v_mov_b32 v80, 1.0
    v_mov_b32 v24, 1.0
    v_mov_b32 v77, 0
    v_mov_b32 v81, 1.0
    v_mov_b32 v25, 1.0
    v_mov_b32 v78, 0
    v_mov_b32 v82, 1.0
    v_mov_b32 v26, 1.0
    v_mov_b32 v79, 0
    v_mov_b32 v83, 1.0
    v_mov_b32 v27, 1.0
    v_mov_b32 v72, 0
    v_mov_b32 v73, 0
    v_mov_b32 v74, 0
    v_mov_b32 v75, 0
    v_mov_b32_dpp v65, v64 row_newbcast:0 row_mask:0xf bank_mask:0xf
    v_mov_b32_dpp v66, v64 row_newbcast:4 row_mask:0xf bank_mask:0xf
    v_mov_b32_dpp v70, v64 row_newbcast:8 row_mask:0xf bank_mask:0xf
    v_mov_b32_dpp v71, v64 row_newbcast:12 row_mask:0xf bank_mask:0xf
    v_mad_u32_u16 v65, v65, 16, v17 op_sel:[1,0,0,0]
    v_mad_u32_u16 v66, v66, 16, v17 op_sel:[1,0,0,0]
    v_mad_u32_u16 v70, v70, 16, v17 op_sel:[1,0,0,0]
    v_mad_u32_u16 v71, v71, 16, v17 op_sel:[1,0,0,0]
    v_mov_b32 v64, 0x40000000
    v_lshrrev_b32 v67, 5, v1
    v_mul_u32_u24 v67, 2112, v67
    v_add_u32 v67, s35, v67
    v_bfe_u32 v69, v1, 2, 2
    v_mul_u32_u24 v69, 528, v69
    v_add_u32 v69, v69, v67
    v_add_u32 v67, v67, v17
    v_subrev_u32 v67, 108544, v67
    v_lshrrev_b32 v19, 2, v0
    v_cmp_gt_u32 s[78:79], s25, v19
    v_mul_u32_u24 v19, 528, v19
    v_add_u32 v19, 108544, v19
    v_and_b32 v31, 2, v0
    v_lshlrev_b32 v31, 6, v31
    v_sub_u32 v31, v28, v31
    v_mad_u32_u16 v56, v56, s30, v60
    v_mad_u32_u16 v57, v57, s30, v61
    v_mad_u32_u16 v58, v58, s30, v62
    v_mad_u32_u16 v59, v59, s30, v63
    v_add_u32 v2, 16, v2
    s_mov_b32 s38, s33
    s_waitcnt vmcnt(0)
    ds_read_b128 v[112:115], v20
    ds_read_b128 v[116:119], v21
    ds_read_b128 v[120:123], v22
    ds_read_b128 v[124:127], v23
    s_cmp_eq_u32 s33, 0
    s_cbranch_scc1 K2_DRAIN
    s_waitcnt lgkmcnt(4)
    v_mfma_f32_32x32x16_bf16 v[192:207], v[100:103], v[104:107], 0
    s_waitcnt lgkmcnt(0)
    v_mfma_f32_32x32x16_bf16 v[208:223], v[112:115], v[160:163], 0
    buffer_load_dwordx4 v56, s[4:7], 0 offen offset:0 lds
    v_mfma_f32_32x32x16_bf16 v[192:207], v[112:115], v[128:131], v[192:207]
    buffer_load_dwordx4 v57, s[4:7], 0 offen offset:1024 lds
    v_mfma_f32_32x32x16_bf16 v[208:223], v[116:119], v[164:167], v[208:223]
    buffer_load_dwordx4 v58, s[4:7], 0 offen offset:2048 lds
    v_mfma_f32_32x32x16_bf16 v[192:207], v[116:119], v[132:135], v[192:207]
    buffer_load_dwordx4 v59, s[4:7], 0 offen offset:3072 lds
    v_mfma_f32_32x32x16_bf16 v[208:223], v[120:123], v[168:171], v[208:223]
    ds_read_b128 v[56:59], v4 offset:1280
    v_mfma_f32_32x32x16_bf16 v[192:207], v[120:123], v[136:139], v[192:207]
    v_mfma_f32_32x32x16_bf16 v[208:223], v[124:127], v[172:175], v[208:223]
    v_mfma_f32_32x32x16_bf16 v[192:207], v[124:127], v[140:143], v[192:207]
    s_waitcnt lgkmcnt(0)
    s_nop 3
    s_mov_b64 s[68:69], 0
    s_cmp_ge_u32 s26, 4
    s_cbranch_scc1 KB_LOOP
    s_branch KA_ENTRY
    .p2align 6
KA_LOOP:
    s_waitcnt lgkmcnt(0)
    v_add_f32 v229, v229, v18
    v_add_f32 v230, v230, v18
    v_add_f32 v231, v231, v18
    v_add_f32 v232, v232, v18
    v_add_f32 v233, v233, v18
    v_add_f32 v234, v234, v18
    v_add_f32 v235, v235, v18
    v_add_f32 v236, v236, v18
    v_add_f32 v237, v237, v18
    v_add_f32 v238, v238, v18
    v_add_f32 v239, v239, v18
    v_fmac_f32 v84, v72, v81
    v_fmac_f32 v85, v76, v81
    v_fmac_f32 v88, v73, v82
    v_fmac_f32 v89, v77, v82
    v_fmac_f32 v92, v74, v83
    v_fmac_f32 v93, v78, v83
    v_fmac_f32 v96, v75, v80
    v_fmac_f32 v97, v79, v80
    v_fmac_f32 v84, v8, v25
    v_fmac_f32 v85, v12, v25
    v_fmac_f32 v88, v9, v26
    v_fmac_f32 v89, v13, v26
    v_fmac_f32 v92, v10, v27
    v_fmac_f32 v93, v14, v27
    v_fmac_f32 v96, v11, v24
    v_fmac_f32 v97, v15, v24
    v_add_u32 v4, 16, v4
    v_add_u32 v2, 16, v2
    v_add_u32 v5, 4, v5
    v_mul_f32 v76, v240, v225
    v_mul_f32 v77, v244, v229
    v_mul_f32 v78, v248, v233
    v_mul_f32 v79, v252, v237
    v_mul_f32 v12, v242, v227
    v_mul_f32 v13, v246, v231
    v_mul_f32 v14, v250, v235
    v_mul_f32 v15, v254, v239
    v_add_f32 v72, v224, v225
    v_add_f32 v73, v228, v229
    v_add_f32 v74, v232, v233
    v_add_f32 v75, v236, v237
    v_add_f32 v8, v226, v227
    v_add_f32 v9, v230, v231
    v_add_f32 v10, v234, v235
    v_add_f32 v11, v238, v239
    v_mul_f32 v81, v224, v225
    v_mul_f32 v82, v228, v229
    v_mul_f32 v83, v232, v233
    v_mul_f32 v80, v236, v237
    v_mul_f32 v25, v226, v227
    v_mul_f32 v26, v230, v231
    v_mul_f32 v27, v234, v235
    v_mul_f32 v24, v238, v239
    v_fmac_f32 v76, v241, v224
    v_fmac_f32 v77, v245, v228
    v_fmac_f32 v78, v249, v232
    v_fmac_f32 v79, v253, v236
    v_fmac_f32 v12, v243, v226
    v_fmac_f32 v13, v247, v230
    v_fmac_f32 v14, v251, v234
    v_fmac_f32 v15, v255, v238
KA_ENTRY:
    s_setprio 2
    v_mfma_f32_32x32x16_bf16 v[224:239], v[100:103], v[108:111], 0
    v_rcp_f32 v81, v81
    v_rcp_f32 v82, v82
    v_rcp_f32 v83, v83
    v_mfma_f32_32x32x16_bf16 v[240:255], v[112:115], v[176:179], 0
    v_rcp_f32 v80, v80
    v_rcp_f32 v25, v25
    v_rcp_f32 v26, v26
    v_mfma_f32_32x32x16_bf16 v[224:239], v[112:115], v[144:147], v[224:239]
    v_rcp_f32 v27, v27
    v_rcp_f32 v24, v24
    v_exp_f32_e64 v192, v192 clamp
    v_mfma_f32_32x32x16_bf16 v[240:255], v[116:119], v[180:183], v[240:255]
    v_exp_f32_e64 v193, v193 clamp
    v_exp_f32_e64 v194, v194 clamp
    v_exp_f32_e64 v195, v195 clamp
    v_mfma_f32_32x32x16_bf16 v[224:239], v[116:119], v[148:151], v[224:239]
    v_exp_f32_e64 v196, v196 clamp
    v_exp_f32_e64 v197, v197 clamp
    v_exp_f32_e64 v198, v198 clamp
    v_mfma_f32_32x32x16_bf16 v[240:255], v[120:123], v[184:187], v[240:255]
    v_exp_f32_e64 v199, v199 clamp
    v_exp_f32_e64 v200, v200 clamp
    v_exp_f32_e64 v201, v201 clamp
    v_mfma_f32_32x32x16_bf16 v[224:239], v[120:123], v[152:155], v[224:239]
    v_exp_f32_e64 v202, v202 clamp
    v_mad_u32_u16 v56, v56, s30, v60
    v_exp_f32_e64 v203, v203 clamp
    v_mad_u32_u16 v57, v57, s30, v61
    v_mfma_f32_32x32x16_bf16 v[240:255], v[124:127], v[188:191], v[240:255]
    v_exp_f32_e64 v204, v204 clamp
    v_mad_u32_u16 v58, v58, s30, v62
    v_exp_f32_e64 v205, v205 clamp
    v_mad_u32_u16 v59, v59, s30, v63
    v_mfma_f32_32x32x16_bf16 v[224:239], v[124:127], v[156:159], v[224:239]
    v_exp_f32_e64 v206, v206 clamp
    v_lshl_add_u32 v3, v3, 3, s42
    v_exp_f32_e64 v207, v207 clamp
    v_add_u32 v6, v6, v7
    s_setprio 0
    s_waitcnt vmcnt(0)
    ds_read_b128 v[112:115], v20
    ds_read_b128 v[116:119], v21
    ds_read_b128 v[120:123], v22
    ds_read_b128 v[124:127], v23
    ds_read_b32 v100, v2 offset:1280
    s_mov_b32 exec_lo, 0
    ds_read_b64 v[100:101], v3
    s_mov_b32 exec_lo, -1
    ds_read_b64_tr_b16 v[106:107], v6 offset:19328
    ds_read_b64_tr_b16 v[110:111], v6 offset:19392
    s_sub_u32 s38, s38, 1
    s_cmp_eq_u32 s38, 0
    s_waitcnt lgkmcnt(4)
    buffer_load_dwordx4 v56, s[4:7], 0 offen offset:0 lds
    buffer_load_dwordx4 v57, s[4:7], 0 offen offset:1024 lds
    buffer_load_dwordx4 v58, s[4:7], 0 offen offset:2048 lds
    buffer_load_dwordx4 v59, s[4:7], 0 offen offset:3072 lds
    s_waitcnt lgkmcnt(0)
    v_add_f32 v192, v192, v18
    v_add_f32 v193, v193, v18
    v_add_f32 v194, v194, v18
    v_add_f32 v195, v195, v18
    v_add_f32 v196, v196, v18
    v_add_f32 v197, v197, v18
    v_add_f32 v198, v198, v18
    v_add_f32 v199, v199, v18
    v_add_f32 v200, v200, v18
    v_add_f32 v201, v201, v18
    v_add_f32 v202, v202, v18
    v_add_f32 v203, v203, v18
    v_add_f32 v204, v204, v18
    v_add_f32 v205, v205, v18
    v_add_f32 v206, v206, v18
    v_add_f32 v207, v207, v18
    v_fmac_f32 v86, v72, v81
    v_fmac_f32 v87, v76, v81
    v_fmac_f32 v90, v73, v82
    v_fmac_f32 v91, v77, v82
    v_fmac_f32 v94, v74, v83
    v_fmac_f32 v95, v78, v83
    v_fmac_f32 v98, v75, v80
    v_fmac_f32 v99, v79, v80
    v_fmac_f32 v86, v8, v25
    v_fmac_f32 v87, v12, v25
    v_fmac_f32 v90, v9, v26
    v_fmac_f32 v91, v13, v26
    v_fmac_f32 v94, v10, v27
    v_fmac_f32 v95, v14, v27
    v_fmac_f32 v98, v11, v24
    v_fmac_f32 v99, v15, v24
    v_mul_f32 v76, v208, v193
    v_mul_f32 v77, v212, v197
    v_mul_f32 v78, v216, v201
    v_mul_f32 v79, v220, v205
    v_mul_f32 v12, v210, v195
    v_mul_f32 v13, v214, v199
    v_mul_f32 v14, v218, v203
    v_mul_f32 v15, v222, v207
    v_add_f32 v72, v192, v193
    v_add_f32 v73, v196, v197
    v_add_f32 v74, v200, v201
    v_add_f32 v75, v204, v205
    v_add_f32 v8, v194, v195
    v_add_f32 v9, v198, v199
    v_add_f32 v10, v202, v203
    v_add_f32 v11, v206, v207
    v_mul_f32 v81, v192, v193
    v_mul_f32 v82, v196, v197
    v_mul_f32 v83, v200, v201
    v_mul_f32 v80, v204, v205
    v_mul_f32 v25, v194, v195
    v_mul_f32 v26, v198, v199
    v_mul_f32 v27, v202, v203
    v_mul_f32 v24, v206, v207
    v_fmac_f32 v76, v209, v192
    v_fmac_f32 v77, v213, v196
    v_fmac_f32 v78, v217, v200
    v_fmac_f32 v79, v221, v204
    v_fmac_f32 v12, v211, v194
    v_fmac_f32 v13, v215, v198
    v_fmac_f32 v14, v219, v202
    v_fmac_f32 v15, v223, v206
    s_cbranch_scc1 KA_LAST
    s_setprio 2
    v_mfma_f32_32x32x16_bf16 v[192:207], v[100:103], v[104:107], 0
    v_rcp_f32 v81, v81
    v_rcp_f32 v82, v82
    v_rcp_f32 v83, v83
    v_mfma_f32_32x32x16_bf16 v[208:223], v[112:115], v[160:163], 0
    v_rcp_f32 v80, v80
    v_rcp_f32 v25, v25
    v_rcp_f32 v26, v26
    v_mfma_f32_32x32x16_bf16 v[192:207], v[112:115], v[128:131], v[192:207]
    v_rcp_f32 v27, v27
    v_rcp_f32 v24, v24
    v_exp_f32_e64 v224, v224 clamp
    v_mfma_f32_32x32x16_bf16 v[208:223], v[116:119], v[164:167], v[208:223]
    v_exp_f32_e64 v225, v225 clamp
    v_exp_f32_e64 v226, v226 clamp
    v_exp_f32_e64 v227, v227 clamp
    v_mfma_f32_32x32x16_bf16 v[192:207], v[116:119], v[132:135], v[192:207]
    v_exp_f32_e64 v228, v228 clamp
    v_exp_f32_e64 v229, v229 clamp
    v_exp_f32_e64 v230, v230 clamp
    v_mfma_f32_32x32x16_bf16 v[208:223], v[120:123], v[168:171], v[208:223]
    v_exp_f32_e64 v231, v231 clamp
    v_exp_f32_e64 v232, v232 clamp
    v_exp_f32_e64 v233, v233 clamp
    v_mfma_f32_32x32x16_bf16 v[192:207], v[120:123], v[136:139], v[192:207]
    v_exp_f32_e64 v234, v234 clamp
    v_cmp_gt_u32 s[68:69], s43, v64
    v_exp_f32_e64 v235, v235 clamp
    v_add_f32 v224, v224, v18
    v_mfma_f32_32x32x16_bf16 v[208:223], v[124:127], v[172:175], v[208:223]
    v_exp_f32_e64 v236, v236 clamp
    v_add_f32 v225, v225, v18
    v_exp_f32_e64 v237, v237 clamp
    v_add_f32 v226, v226, v18
    v_mfma_f32_32x32x16_bf16 v[192:207], v[124:127], v[140:143], v[192:207]
    v_exp_f32_e64 v238, v238 clamp
    v_add_f32 v227, v227, v18
    v_exp_f32_e64 v239, v239 clamp
    v_add_f32 v228, v228, v18
    s_or_b32 s70, s68, s69
    s_cbranch_scc0 KE1
    s_bitcmp0_b32 s70, 0
    s_cbranch_scc1 KW2
    s_bfe_i32 exec_lo, s68, 0x10000
    s_bfe_i32 exec_hi, s69, 0x10000
    ds_write_b128 v65, v[84:87]
    ds_read_b128 v[84:87], v16
    v_add_u32 v65, 528, v65
KW2:
    s_bitcmp0_b32 s70, 4
    s_cbranch_scc1 KW3
    s_bfe_i32 exec_lo, s68, 0x10004
    s_bfe_i32 exec_hi, s69, 0x10004
    ds_write_b128 v66, v[88:91]
    ds_read_b128 v[88:91], v16
    v_add_u32 v66, 528, v66
KW3:
    s_bitcmp0_b32 s70, 8
    s_cbranch_scc1 KW4
    s_bfe_i32 exec_lo, s68, 0x10008
    s_bfe_i32 exec_hi, s69, 0x10008
    ds_write_b128 v70, v[92:95]
    ds_read_b128 v[92:95], v16
    v_add_u32 v70, 528, v70
KW4:
    s_bitcmp0_b32 s70, 12
    s_cbranch_scc1 KW5
    s_bfe_i32 exec_lo, s68, 0x1000c
    s_bfe_i32 exec_hi, s69, 0x1000c
    ds_write_b128 v71, v[96:99]
    ds_read_b128 v[96:99], v16
    v_add_u32 v71, 528, v71
KW5:
    s_mov_b64 exec, -1
KE1:
    s_setprio 0
    ds_read_b32 v64, v5 offset:15676
    ds_read_u16 v6, v5 offset:15684
    ds_read_b128 v[56:59], v4 offset:1296
    ds_read_u16 v3, v2 offset:1298
    s_branch KA_LOOP
KA_LAST:
    s_setprio 2
    v_rcp_f32 v81, v81
    v_rcp_f32 v82, v82
    v_rcp_f32 v83, v83
    v_rcp_f32 v80, v80
    v_rcp_f32 v25, v25
    v_rcp_f32 v26, v26
    v_rcp_f32 v27, v27
    v_rcp_f32 v24, v24
    v_cmp_gt_u32 s[68:69], s43, v64
    v_exp_f32_e64 v224, v224 clamp
    v_exp_f32_e64 v225, v225 clamp
    v_exp_f32_e64 v226, v226 clamp
    v_exp_f32_e64 v227, v227 clamp
    v_exp_f32_e64 v228, v228 clamp
    v_exp_f32_e64 v229, v229 clamp
    v_exp_f32_e64 v230, v230 clamp
    v_exp_f32_e64 v231, v231 clamp
    v_exp_f32_e64 v232, v232 clamp
    v_exp_f32_e64 v233, v233 clamp
    v_exp_f32_e64 v234, v234 clamp
    v_exp_f32_e64 v235, v235 clamp
    v_exp_f32_e64 v236, v236 clamp
    v_exp_f32_e64 v237, v237 clamp
    v_exp_f32_e64 v238, v238 clamp
    v_exp_f32_e64 v239, v239 clamp
    s_setprio 2
    s_or_b32 s70, s68, s69
    s_cbranch_scc0 KE6
    s_bitcmp0_b32 s70, 0
    s_cbranch_scc1 KW7
    s_bfe_i32 exec_lo, s68, 0x10000
    s_bfe_i32 exec_hi, s69, 0x10000
    ds_write_b128 v65, v[84:87]
    ds_read_b128 v[84:87], v16
    v_add_u32 v65, 528, v65
KW7:
    s_bitcmp0_b32 s70, 4
    s_cbranch_scc1 KW8
    s_bfe_i32 exec_lo, s68, 0x10004
    s_bfe_i32 exec_hi, s69, 0x10004
    ds_write_b128 v66, v[88:91]
    ds_read_b128 v[88:91], v16
    v_add_u32 v66, 528, v66
KW8:
    s_bitcmp0_b32 s70, 8
    s_cbranch_scc1 KW9
    s_bfe_i32 exec_lo, s68, 0x10008
    s_bfe_i32 exec_hi, s69, 0x10008
    ds_write_b128 v70, v[92:95]
    ds_read_b128 v[92:95], v16
    v_add_u32 v70, 528, v70
KW9:
    s_bitcmp0_b32 s70, 12
    s_cbranch_scc1 KW10
    s_bfe_i32 exec_lo, s68, 0x1000c
    s_bfe_i32 exec_hi, s69, 0x1000c
    ds_write_b128 v71, v[96:99]
    ds_read_b128 v[96:99], v16
    v_add_u32 v71, 528, v71
KW10:
    s_mov_b64 exec, -1
KE6:
    s_setprio 0
    ds_read_b32 v64, v5 offset:15676
    s_waitcnt lgkmcnt(0)
    v_add_f32 v224, v224, v18
    v_add_f32 v225, v225, v18
    v_add_f32 v226, v226, v18
    v_add_f32 v227, v227, v18
    v_add_f32 v228, v228, v18
    v_add_f32 v229, v229, v18
    v_add_f32 v230, v230, v18
    v_add_f32 v231, v231, v18
    v_add_f32 v232, v232, v18
    v_add_f32 v233, v233, v18
    v_add_f32 v234, v234, v18
    v_add_f32 v235, v235, v18
    v_add_f32 v236, v236, v18
    v_add_f32 v237, v237, v18
    v_add_f32 v238, v238, v18
    v_add_f32 v239, v239, v18
    v_fmac_f32 v84, v72, v81
    v_fmac_f32 v85, v76, v81
    v_fmac_f32 v88, v73, v82
    v_fmac_f32 v89, v77, v82
    v_fmac_f32 v92, v74, v83
    v_fmac_f32 v93, v78, v83
    v_fmac_f32 v96, v75, v80
    v_fmac_f32 v97, v79, v80
    v_fmac_f32 v84, v8, v25
    v_fmac_f32 v85, v12, v25
    v_fmac_f32 v88, v9, v26
    v_fmac_f32 v89, v13, v26
    v_fmac_f32 v92, v10, v27
    v_fmac_f32 v93, v14, v27
    v_fmac_f32 v96, v11, v24
    v_fmac_f32 v97, v15, v24
    v_mul_f32 v76, v240, v225
    v_mul_f32 v77, v244, v229
    v_mul_f32 v78, v248, v233
    v_mul_f32 v79, v252, v237
    v_mul_f32 v12, v242, v227
    v_mul_f32 v13, v246, v231
    v_mul_f32 v14, v250, v235
    v_mul_f32 v15, v254, v239
    v_add_f32 v72, v224, v225
    v_add_f32 v73, v228, v229
    v_add_f32 v74, v232, v233
    v_add_f32 v75, v236, v237
    v_add_f32 v8, v226, v227
    v_add_f32 v9, v230, v231
    v_add_f32 v10, v234, v235
    v_add_f32 v11, v238, v239
    v_mul_f32 v81, v224, v225
    v_mul_f32 v82, v228, v229
    v_mul_f32 v83, v232, v233
    v_mul_f32 v80, v236, v237
    v_mul_f32 v25, v226, v227
    v_mul_f32 v26, v230, v231
    v_mul_f32 v27, v234, v235
    v_mul_f32 v24, v238, v239
    v_fmac_f32 v76, v241, v224
    v_fmac_f32 v77, v245, v228
    v_fmac_f32 v78, v249, v232
    v_fmac_f32 v79, v253, v236
    v_fmac_f32 v12, v243, v226
    v_fmac_f32 v13, v247, v230
    v_fmac_f32 v14, v251, v234
    v_fmac_f32 v15, v255, v238
    s_branch K2_DRAIN
    .p2align 6
KB_LOOP:
    s_setprio 1
    v_mfma_f32_32x32x16_bf16 v[224:239], v[100:103], v[108:111], 0
    v_rcp_f32 v81, v81
    v_rcp_f32 v82, v82
    v_rcp_f32 v83, v83
    v_mfma_f32_32x32x16_bf16 v[240:255], v[112:115], v[176:179], 0
    v_rcp_f32 v80, v80
    v_rcp_f32 v25, v25
    v_rcp_f32 v26, v26
    v_mfma_f32_32x32x16_bf16 v[224:239], v[112:115], v[144:147], v[224:239]
    v_rcp_f32 v27, v27
    v_rcp_f32 v24, v24
    v_exp_f32_e64 v192, v192 clamp
    v_mfma_f32_32x32x16_bf16 v[240:255], v[116:119], v[180:183], v[240:255]
    v_exp_f32_e64 v193, v193 clamp
    v_exp_f32_e64 v194, v194 clamp
    v_exp_f32_e64 v195, v195 clamp
    v_mfma_f32_32x32x16_bf16 v[224:239], v[116:119], v[148:151], v[224:239]
    v_exp_f32_e64 v196, v196 clamp
    v_exp_f32_e64 v197, v197 clamp
    v_exp_f32_e64 v198, v198 clamp
    v_mfma_f32_32x32x16_bf16 v[240:255], v[120:123], v[184:187], v[240:255]
    v_exp_f32_e64 v199, v199 clamp
    v_exp_f32_e64 v200, v200 clamp
    v_exp_f32_e64 v201, v201 clamp
    v_mfma_f32_32x32x16_bf16 v[224:239], v[120:123], v[152:155], v[224:239]
    v_exp_f32_e64 v202, v202 clamp
    v_mad_u32_u16 v56, v56, s30, v60
    v_exp_f32_e64 v203, v203 clamp
    v_mad_u32_u16 v57, v57, s30, v61
    v_mfma_f32_32x32x16_bf16 v[240:255], v[124:127], v[188:191], v[240:255]
    v_exp_f32_e64 v204, v204 clamp
    v_mad_u32_u16 v58, v58, s30, v62
    v_exp_f32_e64 v205, v205 clamp
    v_mad_u32_u16 v59, v59, s30, v63
    v_mfma_f32_32x32x16_bf16 v[224:239], v[124:127], v[156:159], v[224:239]
    v_exp_f32_e64 v206, v206 clamp
    v_lshl_add_u32 v3, v3, 3, s42
    v_exp_f32_e64 v207, v207 clamp
    v_add_u32 v6, v6, v7
    s_setprio 3
    v_add_f32 v192, v192, v18
    v_add_f32 v193, v193, v18
    v_add_f32 v194, v194, v18
    v_add_f32 v195, v195, v18
    v_add_f32 v196, v196, v18
    v_add_f32 v197, v197, v18
    v_add_f32 v198, v198, v18
    v_add_f32 v199, v199, v18
    v_add_f32 v200, v200, v18
    v_add_f32 v201, v201, v18
    v_add_f32 v202, v202, v18
    v_add_f32 v203, v203, v18
    v_add_f32 v204, v204, v18
    v_add_f32 v205, v205, v18
    v_add_f32 v206, v206, v18
    v_add_f32 v207, v207, v18
    v_fmac_f32 v86, v72, v81
    v_fmac_f32 v87, v76, v81
    v_fmac_f32 v90, v73, v82
    v_fmac_f32 v91, v77, v82
    v_fmac_f32 v94, v74, v83
    v_fmac_f32 v95, v78, v83
    v_fmac_f32 v98, v75, v80
    v_fmac_f32 v99, v79, v80
    v_fmac_f32 v86, v8, v25
    v_fmac_f32 v87, v12, v25
    v_fmac_f32 v90, v9, v26
    v_fmac_f32 v91, v13, v26
    v_fmac_f32 v94, v10, v27
    v_fmac_f32 v95, v14, v27
    v_fmac_f32 v98, v11, v24
    v_fmac_f32 v99, v15, v24
    v_mul_f32 v76, v208, v193
    v_mul_f32 v77, v212, v197
    v_mul_f32 v78, v216, v201
    v_mul_f32 v79, v220, v205
    v_mul_f32 v12, v210, v195
    v_mul_f32 v13, v214, v199
    v_mul_f32 v14, v218, v203
    v_mul_f32 v15, v222, v207
    v_add_f32 v72, v192, v193
    v_add_f32 v73, v196, v197
    v_add_f32 v74, v200, v201
    v_add_f32 v75, v204, v205
    v_add_f32 v8, v194, v195
    v_add_f32 v9, v198, v199
    v_add_f32 v10, v202, v203
    v_add_f32 v11, v206, v207
    v_mul_f32 v81, v192, v193
    v_mul_f32 v82, v196, v197
    v_mul_f32 v83, v200, v201
    v_mul_f32 v80, v204, v205
    v_mul_f32 v25, v194, v195
    v_mul_f32 v26, v198, v199
    v_mul_f32 v27, v202, v203
    v_mul_f32 v24, v206, v207
    v_fmac_f32 v76, v209, v192
    v_fmac_f32 v77, v213, v196
    v_fmac_f32 v78, v217, v200
    v_fmac_f32 v79, v221, v204
    v_fmac_f32 v12, v211, v194
    v_fmac_f32 v13, v215, v198
    v_fmac_f32 v14, v219, v202
    v_fmac_f32 v15, v223, v206
    s_or_b32 s70, s68, s69
    s_cbranch_scc0 KE11
    s_bitcmp0_b32 s70, 0
    s_cbranch_scc1 KW12
    s_bfe_i32 exec_lo, s68, 0x10000
    s_bfe_i32 exec_hi, s69, 0x10000
    ds_write_b128 v65, v[84:87]
    ds_read_b128 v[84:87], v16
    v_add_u32 v65, 528, v65
KW12:
    s_bitcmp0_b32 s70, 4
    s_cbranch_scc1 KW13
    s_bfe_i32 exec_lo, s68, 0x10004
    s_bfe_i32 exec_hi, s69, 0x10004
    ds_write_b128 v66, v[88:91]
    ds_read_b128 v[88:91], v16
    v_add_u32 v66, 528, v66
KW13:
    s_bitcmp0_b32 s70, 8
    s_cbranch_scc1 KW14
    s_bfe_i32 exec_lo, s68, 0x10008
    s_bfe_i32 exec_hi, s69, 0x10008
    ds_write_b128 v70, v[92:95]
    ds_read_b128 v[92:95], v16
    v_add_u32 v70, 528, v70
KW14:
    s_bitcmp0_b32 s70, 12
    s_cbranch_scc1 KW15
    s_bfe_i32 exec_lo, s68, 0x1000c
    s_bfe_i32 exec_hi, s69, 0x1000c
    ds_write_b128 v71, v[96:99]
    ds_read_b128 v[96:99], v16
    v_add_u32 v71, 528, v71
KW15:
    s_mov_b64 exec, -1
KE11:
    ds_read_b32 v64, v5 offset:15676
    s_sub_u32 s38, s38, 1
    s_cmp_eq_u32 s38, 0
    s_cbranch_scc1 KB_LAST
    ds_read_b32 v100, v2 offset:1280
    s_mov_b32 exec_lo, 0
    ds_read_b64 v[100:101], v3
    s_mov_b32 exec_lo, -1
    ds_read_b64_tr_b16 v[106:107], v6 offset:19328
    s_waitcnt vmcnt(0)
    ds_read_b128 v[112:115], v20
    ds_read_b128 v[116:119], v21
    ds_read_b128 v[120:123], v22
    ds_read_b128 v[124:127], v23
    s_waitcnt lgkmcnt(3)
    s_setprio 1
    v_mfma_f32_32x32x16_bf16 v[192:207], v[100:103], v[104:107], 0
    v_exp_f32_e64 v224, v224 clamp
    v_exp_f32_e64 v225, v225 clamp
    v_exp_f32_e64 v226, v226 clamp
    v_mfma_f32_32x32x16_bf16 v[208:223], v[112:115], v[160:163], 0
    v_exp_f32_e64 v227, v227 clamp
    v_rcp_f32 v81, v81
    v_rcp_f32 v82, v82
    v_mfma_f32_32x32x16_bf16 v[192:207], v[112:115], v[128:131], v[192:207]
    v_rcp_f32 v83, v83
    v_add_f32 v224, v224, v18
    v_rcp_f32 v80, v80
    s_waitcnt lgkmcnt(0)
    v_mfma_f32_32x32x16_bf16 v[208:223], v[116:119], v[164:167], v[208:223]
    v_rcp_f32 v25, v25
    v_rcp_f32 v26, v26
    v_rcp_f32 v27, v27
    v_mfma_f32_32x32x16_bf16 v[192:207], v[116:119], v[132:135], v[192:207]
    v_rcp_f32 v24, v24
    v_exp_f32_e64 v228, v228 clamp
    v_exp_f32_e64 v229, v229 clamp
    v_mfma_f32_32x32x16_bf16 v[208:223], v[120:123], v[168:171], v[208:223]
    v_exp_f32_e64 v230, v230 clamp
    v_exp_f32_e64 v231, v231 clamp
    v_exp_f32_e64 v232, v232 clamp
    v_mfma_f32_32x32x16_bf16 v[192:207], v[120:123], v[136:139], v[192:207]
    v_exp_f32_e64 v233, v233 clamp
    v_exp_f32_e64 v234, v234 clamp
    v_exp_f32_e64 v235, v235 clamp
    v_mfma_f32_32x32x16_bf16 v[208:223], v[124:127], v[172:175], v[208:223]
    v_exp_f32_e64 v236, v236 clamp
    v_cmp_gt_u32 s[68:69], s43, v64
    v_exp_f32_e64 v237, v237 clamp
    v_add_f32 v225, v225, v18
    v_mfma_f32_32x32x16_bf16 v[192:207], v[124:127], v[140:143], v[192:207]
    v_exp_f32_e64 v238, v238 clamp
    v_add_f32 v226, v226, v18
    v_exp_f32_e64 v239, v239 clamp
    v_add_f32 v227, v227, v18
    s_setprio 3
    v_add_f32 v228, v228, v18
    v_add_f32 v229, v229, v18
    v_add_f32 v230, v230, v18
    v_add_f32 v231, v231, v18
    v_add_f32 v232, v232, v18
    v_add_f32 v233, v233, v18
    v_add_f32 v234, v234, v18
    v_add_f32 v235, v235, v18
    v_add_f32 v236, v236, v18
    v_add_f32 v237, v237, v18
    v_add_f32 v238, v238, v18
    v_add_f32 v239, v239, v18
    v_fmac_f32 v84, v72, v81
    v_fmac_f32 v85, v76, v81
    v_fmac_f32 v88, v73, v82
    v_fmac_f32 v89, v77, v82
    v_fmac_f32 v92, v74, v83
    v_fmac_f32 v93, v78, v83
    v_fmac_f32 v96, v75, v80
    v_fmac_f32 v97, v79, v80
    v_fmac_f32 v84, v8, v25
    v_fmac_f32 v85, v12, v25
    v_fmac_f32 v88, v9, v26
    v_fmac_f32 v89, v13, v26
    v_fmac_f32 v92, v10, v27
    v_fmac_f32 v93, v14, v27
    v_fmac_f32 v96, v11, v24
    v_fmac_f32 v97, v15, v24
    v_add_u32 v4, 16, v4
    v_add_u32 v2, 16, v2
    v_add_u32 v5, 4, v5
    v_mul_f32 v76, v240, v225
    v_mul_f32 v77, v244, v229
    v_mul_f32 v78, v248, v233
    v_mul_f32 v79, v252, v237
    v_mul_f32 v12, v242, v227
    v_mul_f32 v13, v246, v231
    v_mul_f32 v14, v250, v235
    v_mul_f32 v15, v254, v239
    v_add_f32 v72, v224, v225
    v_add_f32 v73, v228, v229
    v_add_f32 v74, v232, v233
    v_add_f32 v75, v236, v237
    v_add_f32 v8, v226, v227
    v_add_f32 v9, v230, v231
    v_add_f32 v10, v234, v235
    v_add_f32 v11, v238, v239
    v_mul_f32 v81, v224, v225
    v_mul_f32 v82, v228, v229
    v_mul_f32 v83, v232, v233
    v_mul_f32 v80, v236, v237
    v_mul_f32 v25, v226, v227
    v_mul_f32 v26, v230, v231
    v_mul_f32 v27, v234, v235
    v_mul_f32 v24, v238, v239
    v_fmac_f32 v76, v241, v224
    v_fmac_f32 v77, v245, v228
    v_fmac_f32 v78, v249, v232
    v_fmac_f32 v79, v253, v236
    v_fmac_f32 v12, v243, v226
    v_fmac_f32 v13, v247, v230
    v_fmac_f32 v14, v251, v234
    v_fmac_f32 v15, v255, v238
    buffer_load_dwordx4 v56, s[4:7], 0 offen offset:0 lds
    buffer_load_dwordx4 v57, s[4:7], 0 offen offset:1024 lds
    buffer_load_dwordx4 v58, s[4:7], 0 offen offset:2048 lds
    buffer_load_dwordx4 v59, s[4:7], 0 offen offset:3072 lds
    ds_read_b64_tr_b16 v[110:111], v6 offset:19392
    ds_read_u16 v6, v5 offset:15680
    ds_read_u16 v3, v2 offset:1282
    ds_read_b128 v[56:59], v4 offset:1280
    s_waitcnt lgkmcnt(0)
    s_branch KB_LOOP
KB_LAST:
    s_setprio 1
    v_rcp_f32 v81, v81
    v_rcp_f32 v82, v82
    v_rcp_f32 v83, v83
    v_rcp_f32 v80, v80
    v_rcp_f32 v25, v25
    v_rcp_f32 v26, v26
    v_rcp_f32 v27, v27
    v_rcp_f32 v24, v24
    v_exp_f32_e64 v224, v224 clamp
    v_exp_f32_e64 v225, v225 clamp
    v_exp_f32_e64 v226, v226 clamp
    v_exp_f32_e64 v227, v227 clamp
    v_exp_f32_e64 v228, v228 clamp
    v_exp_f32_e64 v229, v229 clamp
    v_exp_f32_e64 v230, v230 clamp
    v_exp_f32_e64 v231, v231 clamp
    v_exp_f32_e64 v232, v232 clamp
    v_exp_f32_e64 v233, v233 clamp
    v_exp_f32_e64 v234, v234 clamp
    v_exp_f32_e64 v235, v235 clamp
    v_exp_f32_e64 v236, v236 clamp
    v_exp_f32_e64 v237, v237 clamp
    v_exp_f32_e64 v238, v238 clamp
    v_exp_f32_e64 v239, v239 clamp
    s_setprio 3
    s_waitcnt lgkmcnt(0)
    v_add_f32 v224, v224, v18
    v_add_f32 v225, v225, v18
    v_add_f32 v226, v226, v18
    v_add_f32 v227, v227, v18
    v_add_f32 v228, v228, v18
    v_add_f32 v229, v229, v18
    v_add_f32 v230, v230, v18
    v_add_f32 v231, v231, v18
    v_add_f32 v232, v232, v18
    v_add_f32 v233, v233, v18
    v_add_f32 v234, v234, v18
    v_add_f32 v235, v235, v18
    v_add_f32 v236, v236, v18
    v_add_f32 v237, v237, v18
    v_add_f32 v238, v238, v18
    v_add_f32 v239, v239, v18
    v_fmac_f32 v84, v72, v81
    v_fmac_f32 v85, v76, v81
    v_fmac_f32 v88, v73, v82
    v_fmac_f32 v89, v77, v82
    v_fmac_f32 v92, v74, v83
    v_fmac_f32 v93, v78, v83
    v_fmac_f32 v96, v75, v80
    v_fmac_f32 v97, v79, v80
    v_fmac_f32 v84, v8, v25
    v_fmac_f32 v85, v12, v25
    v_fmac_f32 v88, v9, v26
    v_fmac_f32 v89, v13, v26
    v_fmac_f32 v92, v10, v27
    v_fmac_f32 v93, v14, v27
    v_fmac_f32 v96, v11, v24
    v_fmac_f32 v97, v15, v24
    v_mul_f32 v76, v240, v225
    v_mul_f32 v77, v244, v229
    v_mul_f32 v78, v248, v233
    v_mul_f32 v79, v252, v237
    v_mul_f32 v12, v242, v227
    v_mul_f32 v13, v246, v231
    v_mul_f32 v14, v250, v235
    v_mul_f32 v15, v254, v239
    v_add_f32 v72, v224, v225
    v_add_f32 v73, v228, v229
    v_add_f32 v74, v232, v233
    v_add_f32 v75, v236, v237
    v_add_f32 v8, v226, v227
    v_add_f32 v9, v230, v231
    v_add_f32 v10, v234, v235
    v_add_f32 v11, v238, v239
    v_mul_f32 v81, v224, v225
    v_mul_f32 v82, v228, v229
    v_mul_f32 v83, v232, v233
    v_mul_f32 v80, v236, v237
    v_mul_f32 v25, v226, v227
    v_mul_f32 v26, v230, v231
    v_mul_f32 v27, v234, v235
    v_mul_f32 v24, v238, v239
    v_fmac_f32 v76, v241, v224
    v_fmac_f32 v77, v245, v228
    v_fmac_f32 v78, v249, v232
    v_fmac_f32 v79, v253, v236
    v_fmac_f32 v12, v243, v226
    v_fmac_f32 v13, v247, v230
    v_fmac_f32 v14, v251, v234
    v_fmac_f32 v15, v255, v238
K2_DRAIN:
    s_setprio 0
    v_rcp_f32 v81, v81
    v_rcp_f32 v82, v82
    v_rcp_f32 v83, v83
    v_rcp_f32 v80, v80
    v_rcp_f32 v25, v25
    v_rcp_f32 v26, v26
    v_rcp_f32 v27, v27
    v_rcp_f32 v24, v24
    v_cmp_gt_u32 s[68:69], s43, v64
    v_cmp_gt_i32 s[76:77], 0, v64
    v_and_b32 v30, 0x3fffffff, v64
    s_mov_b32 s40, 109056
    v_mad_u32_u16 v68, v30, 16, s40 op_sel:[1,0,0,0]
    s_lshl_b32 s40, s37, 2
    v_and_or_b32 v68, v1, s40, v68
    v_fmac_f32 v86, v72, v81
    v_fmac_f32 v87, v76, v81
    v_fmac_f32 v90, v73, v82
    v_fmac_f32 v91, v77, v82
    v_fmac_f32 v94, v74, v83
    v_fmac_f32 v95, v78, v83
    v_fmac_f32 v98, v75, v80
    v_fmac_f32 v99, v79, v80
    v_fmac_f32 v86, v8, v25
    v_fmac_f32 v87, v12, v25
    v_fmac_f32 v90, v9, v26
    v_fmac_f32 v91, v13, v26
    v_fmac_f32 v94, v10, v27
    v_fmac_f32 v95, v14, v27
    v_fmac_f32 v98, v11, v24
    v_fmac_f32 v99, v15, v24
    s_or_b32 s70, s68, s69
    s_cbranch_scc0 KE16
    s_bitcmp0_b32 s70, 0
    s_cbranch_scc1 KW17
    s_bfe_i32 exec_lo, s68, 0x10000
    s_bfe_i32 exec_hi, s69, 0x10000
    ds_write_b128 v65, v[84:87]
KW17:
    s_bitcmp0_b32 s70, 4
    s_cbranch_scc1 KW18
    s_bfe_i32 exec_lo, s68, 0x10004
    s_bfe_i32 exec_hi, s69, 0x10004
    ds_write_b128 v66, v[88:91]
KW18:
    s_bitcmp0_b32 s70, 8
    s_cbranch_scc1 KW19
    s_bfe_i32 exec_lo, s68, 0x10008
    s_bfe_i32 exec_hi, s69, 0x10008
    ds_write_b128 v70, v[92:95]
KW19:
    s_bitcmp0_b32 s70, 12
    s_cbranch_scc1 KW20
    s_bfe_i32 exec_lo, s68, 0x1000c
    s_bfe_i32 exec_hi, s69, 0x1000c
    ds_write_b128 v71, v[96:99]
KW20:
    s_mov_b64 exec, -1
KE16:
    s_cmp_eq_u32 s37, 2
    s_cbranch_scc1 K2_TAILAT
    s_cmp_eq_u32 s37, 0
    s_cselect_b32 s41, s80, 0
    s_waitcnt vmcnt(0)
    v_add_f32 v84, s80, v84
    v_add_f32 v86, s80, v86
    ds_write_b128 v67, v[84:87] offset:0
    v_add_f32 v88, s41, v88
    v_add_f32 v90, s41, v90
    ds_write_b128 v67, v[88:91] offset:528
    v_add_f32 v92, s80, v92
    v_add_f32 v94, s80, v94
    ds_write_b128 v67, v[92:95] offset:1056
    v_add_f32 v96, s41, v96
    v_add_f32 v98, s41, v98
    ds_write_b128 v67, v[96:99] offset:1584
    s_mov_b64 exec, s[76:77]
    ds_write_b32 v68, v69
K2_TAILD:
    s_mov_b64 exec, -1
    s_mov_b32 s41, 0x100000
    v_sub_u32 v13, v28, v19
    v_sub_u32 v14, v31, v19
    s_cmp_eq_u32 s36, 0
    s_cselect_b32 s40, s29, 0
    s_cmp_eq_u32 s37, 1
    s_waitcnt lgkmcnt(0)
    s_barrier
    s_mov_b64 exec, s[78:79]
    s_cbranch_execz K2_TAIL2D
    ds_read_b64 v[10:11], v19 offset:512
    ds_read_b128 v[192:195], v28 offset:0
    ds_read_b128 v[196:199], v28 offset:16
    ds_read_b128 v[200:203], v28 offset:32
    ds_read_b128 v[204:207], v28 offset:48
    ds_read_b128 v[208:211], v31 offset:64
    ds_read_b128 v[212:215], v31 offset:80
    ds_read_b128 v[216:219], v31 offset:96
    ds_read_b128 v[220:223], v31 offset:112
    s_waitcnt lgkmcnt(8)
    v_cmp_gt_u32 vcc, s41, v10
    v_add_u32 v12, v13, v10
    v_add_u32 v15, v14, v10
    s_mov_b64 exec, vcc
    ds_read_b128 v[224:227], v12 offset:0
    ds_read_b128 v[228:231], v12 offset:16
    ds_read_b128 v[232:235], v12 offset:32
    ds_read_b128 v[236:239], v12 offset:48
    ds_read_b128 v[240:243], v15 offset:64
    ds_read_b128 v[244:247], v15 offset:80
    ds_read_b128 v[248:251], v15 offset:96
    ds_read_b128 v[252:255], v15 offset:112
    s_waitcnt lgkmcnt(7)
    v_pk_add_f32 v[192:193], v[192:193], v[224:225]
    v_pk_add_f32 v[194:195], v[194:195], v[226:227]
    s_waitcnt lgkmcnt(6)
    v_pk_add_f32 v[196:197], v[196:197], v[228:229]
    v_pk_add_f32 v[198:199], v[198:199], v[230:231]
    s_waitcnt lgkmcnt(5)
    v_pk_add_f32 v[200:201], v[200:201], v[232:233]
    v_pk_add_f32 v[202:203], v[202:203], v[234:235]
    s_waitcnt lgkmcnt(4)
    v_pk_add_f32 v[204:205], v[204:205], v[236:237]
    v_pk_add_f32 v[206:207], v[206:207], v[238:239]
    s_waitcnt lgkmcnt(3)
    v_pk_add_f32 v[208:209], v[208:209], v[240:241]
    v_pk_add_f32 v[210:211], v[210:211], v[242:243]
    s_waitcnt lgkmcnt(2)
    v_pk_add_f32 v[212:213], v[212:213], v[244:245]
    v_pk_add_f32 v[214:215], v[214:215], v[246:247]
    s_waitcnt lgkmcnt(1)
    v_pk_add_f32 v[216:217], v[216:217], v[248:249]
    v_pk_add_f32 v[218:219], v[218:219], v[250:251]
    s_waitcnt lgkmcnt(0)
    v_pk_add_f32 v[220:221], v[220:221], v[252:253]
    v_pk_add_f32 v[222:223], v[222:223], v[254:255]
    s_mov_b64 exec, s[78:79]
    s_cbranch_scc1 K2_TAIL2
K2_TAIL2D:
    s_cmp_eq_u32 s40, 0
    s_cbranch_scc1 K2_SLOWTOT
K2_FIN:
    s_mov_b64 exec, s[78:79]
    s_cbranch_execz K2_DONE
    v_rcp_f32 v192, v192
    v_rcp_f32 v196, v196
    v_rcp_f32 v200, v200
    v_rcp_f32 v204, v204
    v_rcp_f32 v208, v208
    v_rcp_f32 v212, v212
    v_rcp_f32 v216, v216
    v_rcp_f32 v220, v220
    s_nop 0
    v_fmac_f32 v40, v192, v193
    v_fmac_f32 v41, v196, v197
    v_fmac_f32 v42, v200, v201
    v_fmac_f32 v43, v204, v205
    v_fmac_f32 v44, v208, v209
    v_fmac_f32 v45, v212, v213
    v_fmac_f32 v46, v216, v217
    v_fmac_f32 v47, v220, v221
    v_cvt_pk_bf16_f32 v112, v40, v41
    v_cvt_pk_bf16_f32 v113, v42, v43
    v_cvt_pk_bf16_f32 v114, v44, v45
    v_cvt_pk_bf16_f32 v115, v46, v47
    v_pk_max_f16 v112, v112, v32
    v_pk_max_f16 v113, v113, v33
    v_pk_max_f16 v114, v114, v34
    v_pk_max_f16 v115, v115, v35
    buffer_store_dwordx4 v[112:115], v29, s[16:19], 0 offen offset:0 sc1
    v_rcp_f32 v194, v194
    v_rcp_f32 v198, v198
    v_rcp_f32 v202, v202
    v_rcp_f32 v206, v206
    v_rcp_f32 v210, v210
    v_rcp_f32 v214, v214
    v_rcp_f32 v218, v218
    v_rcp_f32 v222, v222
    s_nop 0
    v_fmac_f32 v48, v194, v195
    v_fmac_f32 v49, v198, v199
    v_fmac_f32 v50, v202, v203
    v_fmac_f32 v51, v206, v207
    v_fmac_f32 v52, v210, v211
    v_fmac_f32 v53, v214, v215
    v_fmac_f32 v54, v218, v219
    v_fmac_f32 v55, v222, v223
    v_cvt_pk_bf16_f32 v116, v48, v49
    v_cvt_pk_bf16_f32 v117, v50, v51
    v_cvt_pk_bf16_f32 v118, v52, v53
    v_cvt_pk_bf16_f32 v119, v54, v55
    v_pk_max_f16 v116, v116, v36
    v_pk_max_f16 v117, v117, v37
    v_pk_max_f16 v118, v118, v38
    v_pk_max_f16 v119, v119, v39
    buffer_store_dwordx4 v[116:119], v29, s[16:19], 0 offen offset:64 sc1
K2_DONE:
K2_END:
    s_endpgm
P1_W7A:
    s_barrier
    ds_read_b128 v[240:243], v69
    s_waitcnt lgkmcnt(0)
    v_add_u32 v72, v240, v241
    v_add_u32 v73, v72, v242
    v_add_u32 v76, v73, v243
    v_mov_b32 v80, v76
    s_nop 1
    v_add_u32_dpp v80, v80, v80 row_shr:1 row_mask:0xf bank_mask:0xf
    s_nop 1
    v_add_u32_dpp v80, v80, v80 row_shr:2 row_mask:0xf bank_mask:0xf
    s_nop 1
    v_add_u32_dpp v80, v80, v80 row_shr:4 row_mask:0xf bank_mask:0xf
    s_nop 1
    v_add_u32_dpp v80, v80, v80 row_shr:8 row_mask:0xf bank_mask:0xf
    s_nop 1
    v_add_u32_dpp v80, v80, v80 row_bcast:15 row_mask:0xa bank_mask:0xf
    s_nop 1
    v_add_u32_dpp v80, v80, v80 row_bcast:31 row_mask:0xc bank_mask:0xf
    v_sub_u32 v244, v80, v76
    v_add_u32 v245, v244, v240
    v_add_u32 v246, v244, v72
    v_add_u32 v247, v244, v73
    s_cmp_lt_u32 s3, 64
    s_cbranch_scc0 P1_NOF
    s_lshl_b32 s39, s3, 2
    v_mov_b32 v76, 1
    s_mov_b64 exec, 1
    s_waitcnt vmcnt(0)
    buffer_store_dword v76, v74, s[20:23], s39 offen sc1
    s_mov_b64 exec, -1
P1_NOF:
    s_mov_b32 s68, s64
    s_and_b32 s69, s65, 0xffff
    s_mov_b32 s70, 512
    s_mov_b32 s71, 0x20000
    buffer_load_dwordx4 v[224:227], v68, s[68:71], 0 offen
    s_lshl_b32 s40, s26, 10
    s_add_u32 m0, s40, 81920
    s_mov_b32 s68, s52
    s_and_b32 s69, s53, 0xffff
    s_mov_b32 s70, 8192
    s_mov_b32 s71, 0x20000
    buffer_load_dwordx4 v82, s[68:71], s40 offen lds
    s_add_u32 m0, s40, 90112
    s_mov_b32 s68, s60
    s_and_b32 s69, s61, 0xffff
    s_mov_b32 s70, 8192
    s_mov_b32 s71, 0x20000
    buffer_load_dwordx4 v82, s[68:71], s40 offen lds
    s_add_u32 m0, s40, 98304
    s_mov_b32 s68, s66
    s_and_b32 s69, s67, 0xffff
    s_mov_b32 s70, 8192
    s_mov_b32 s71, 0x20000
    buffer_load_dwordx4 v82, s[68:71], s40 offen lds
    s_lshl_b32 s40, s26, 10
    s_mov_b32 s68, s62
    s_and_b32 s69, s63, 0xffff
    s_mov_b32 s70, 8192
    s_mov_b32 s71, 0x20000
    buffer_load_dwordx4 v[112:115], v82, s[68:71], s40 offen
    v_and_b32 v67, 31, v1
    v_bfe_u32 v70, v1, 2, 1
    v_bfe_u32 v71, v1, 3, 2
    v_and_b32 v72, 1, v71
    v_lshlrev_b32 v72, 4, v72
    v_mov_b32 v73, 0x3f80
    v_cmp_eq_u32 vcc, v70, v81
    v_lshlrev_b32 v72, v72, v73
    v_cmp_gt_u32 s[42:43], 2, v71
    v_cndmask_b32 v72, 0, v72, vcc
    v_and_b32 v73, 3, v1
    v_cndmask_b32 v102, 0, v72, s[42:43]
    v_cndmask_b32 v103, v72, 0, s[42:43]
    v_mov_b32 v101, 0x3f80
    v_xor_b32 v74, 0, v77
    v_lshlrev_b32 v74, 4, v74
    v_add_u32 v60, 3072, v74
    v_xor_b32 v74, 1, v77
    v_lshlrev_b32 v74, 4, v74
    v_add_u32 v61, 2048, v74
    v_xor_b32 v74, 2, v77
    v_lshlrev_b32 v74, 4, v74
    v_add_u32 v62, 1024, v74
    v_xor_b32 v74, 3, v77
    v_lshlrev_b32 v74, 4, v74
    v_add_u32 v63, 0, v74
    v_bfe_u32 v74, v1, 2, 3
    v_bfe_u32 v75, v1, 4, 1
    v_lshl_add_u32 v72, v75, 2, v73
    v_lshlrev_b32 v76, 10, v73
    v_lshl_add_u32 v76, v74, 7, v76
    v_add_u32 v76, s35, v76
    v_xor_b32 v72, v72, v81
    v_xor_b32 v74, 0, v72
    v_lshl_add_u32 v20, v74, 4, v76
    v_xor_b32 v74, 2, v72
    v_lshl_add_u32 v21, v74, 4, v76
    v_xor_b32 v74, 4, v72
    v_lshl_add_u32 v22, v74, 4, v76
    v_xor_b32 v74, 6, v72
    v_lshl_add_u32 v23, v74, 4, v76
    v_lshlrev_b32 v17, 2, v75
    v_xor_b32 v17, v17, v67
    v_lshlrev_b32 v17, 4, v17
    v_add_u32 v17, 108544, v17
    v_mov_b32 v18, 0x27800000
    v_mov_b32 v16, 1056
    v_lshlrev_b32 v73, 3, v73
    v_lshl_add_u32 v7, v75, 5, v73
    s_and_b32 s41, s26, 1
    s_lshr_b32 s39, s26, 1
    s_lshl_b32 s40, s39, 5
    v_add_u32 v252, s40, v67
    v_mov_b32 v254, v252
    v_mul_u32_u24 v252, 136, v252
    v_lshl_add_u32 v252, v81, 3, v252
    s_lshl_b32 s41, s41, 6
    v_add_u32 v252, s41, v252
    v_bfe_u32 v71, v1, 2, 2
    v_lshl_add_u32 v253, v81, 2, v71
    v_lshl_add_u32 v253, v253, 7, v7
    v_add_u32 v253, 124928, v253
    v_lshl_add_u32 v249, v81, 3, v71
    v_lshl_add_u32 v249, v249, 7, v7
    v_bfe_u32 v71, v1, 3, 1
    v_lshl_add_u32 v249, v71, 6, v249
    v_add_u32 v249, 73728, v249
    v_xor_b32 v250, 64, v249
    v_xor_b32 v251, s41, v249
    s_mul_i32 s34, s26, 5120
    s_add_u32 s34, s34, 32768
    s_sub_u32 s39, s34, s35
    v_add_u32 v24, s39, v20
    v_add_u32 v25, s39, v21
    v_add_u32 v26, s39, v22
    v_add_u32 v27, s39, v23
    s_add_u32 s40, s40, s24
    v_lshrrev_b32 v71, 3, v1
    v_lshl_add_u32 v56, v71, 2, s40
    v_add_u32 v57, 1, v56
    v_add_u32 v58, 2, v56
    v_add_u32 v59, 3, v56
    v_mad_u32_u16 v56, v56, s30, v60
    v_mad_u32_u16 v57, v57, s30, v61
    v_mad_u32_u16 v58, v58, s30, v62
    v_mad_u32_u16 v59, v59, s30, v63
    v_lshl_or_b32 v244, v240, 16, v244
    v_or_b32 v244, 1, v244
    v_lshl_or_b32 v245, v241, 16, v245
    v_or_b32 v245, 1, v245
    v_lshl_or_b32 v246, v242, 16, v246
    v_or_b32 v246, 1, v246
    v_lshl_or_b32 v247, v243, 16, v247
    v_or_b32 v247, 1, v247
    s_branch P1_J
P1_W7B:
    s_mov_b32 s16, s54
    s_and_b32 s17, s55, 0xffff
    s_mov_b32 s18, 3200000
    s_mov_b32 s19, 0x20000
    v_mov_b32 v74, 0xbfb8aa3b
    v_add_u32 v75, 73728, v64
    s_waitcnt vmcnt(5)
    v_lshlrev_b32 v72, 16, v112
    v_and_b32 v73, 0xffff0000, v112
    v_mul_f32 v72, v74, v72
    v_mul_f32 v73, v74, v73
    v_cvt_pk_bf16_f32 v112, v72, v73
    v_lshlrev_b32 v72, 16, v113
    v_and_b32 v73, 0xffff0000, v113
    v_mul_f32 v72, v74, v72
    v_mul_f32 v73, v74, v73
    v_cvt_pk_bf16_f32 v113, v72, v73
    v_lshlrev_b32 v72, 16, v114
    v_and_b32 v73, 0xffff0000, v114
    v_mul_f32 v72, v74, v72
    v_mul_f32 v73, v74, v73
    v_cvt_pk_bf16_f32 v114, v72, v73
    v_lshlrev_b32 v72, 16, v115
    v_and_b32 v73, 0xffff0000, v115
    v_mul_f32 v72, v74, v72
    v_mul_f32 v73, v74, v73
    v_cvt_pk_bf16_f32 v115, v72, v73
    ds_write_b128 v75, v[112:115]
    v_lshlrev_b32 v72, 16, v224
    v_and_b32 v73, 0xffff0000, v224
    v_mul_f32 v72, v74, v72
    v_mul_f32 v73, v74, v73
    v_cvt_pk_bf16_f32 v224, v72, v73
    v_lshlrev_b32 v72, 16, v225
    v_and_b32 v73, 0xffff0000, v225
    v_mul_f32 v72, v74, v72
    v_mul_f32 v73, v74, v73
    v_cvt_pk_bf16_f32 v225, v72, v73
    v_lshlrev_b32 v72, 16, v226
    v_and_b32 v73, 0xffff0000, v226
    v_mul_f32 v72, v74, v72
    v_mul_f32 v73, v74, v73
    v_cvt_pk_bf16_f32 v226, v72, v73
    v_lshlrev_b32 v72, 16, v227
    v_and_b32 v73, 0xffff0000, v227
    v_mul_f32 v72, v74, v72
    v_mul_f32 v73, v74, v73
    v_cvt_pk_bf16_f32 v227, v72, v73
    v_lshrrev_b32 v73, 3, v1
    v_cmp_eq_u32 vcc, 5, v73
    v_mov_b32 v72, 0x21802180
    v_xor_b32 v73, 512, v68
    v_cndmask_b32 v224, v224, v72, vcc
    v_cndmask_b32 v225, v225, v72, vcc
    v_cndmask_b32 v226, v226, v72, vcc
    v_cndmask_b32 v227, v227, v72, vcc
    s_bfm_b64 exec, 8, 48
    v_mov_b32 v224, 0xc240c240
    v_mov_b32 v225, 0xc240c240
    v_mov_b32 v226, 0xc240c240
    v_mov_b32 v227, 0xc240c240
    s_mov_b64 exec, -1
    v_add_u32 v73, 124928, v73
    ds_write_b128 v73, v[224:227]
    v_lshrrev_b32 v13, 2, v0
    v_and_b32 v14, 3, v0
    v_add_u32 v29, s24, v13
    v_lshlrev_b32 v29, 7, v29
    v_lshl_add_u32 v29, v14, 4, v29
    v_mul_u32_u24 v28, 528, v13
    v_lshl_add_u32 v28, v14, 7, v28
    v_add_u32 v28, 108544, v28
    v_lshrrev_b32 v15, 1, v14
    v_lshl_add_u32 v28, v15, 6, v28
    v_and_b32 v15, 7, v13
    v_lshlrev_b32 v14, 1, v14
    v_xor_b32 v14, v14, v15
    v_lshlrev_b32 v14, 4, v14
    v_lshl_add_u32 v30, v13, 8, v14
    v_add_u32 v30, 128000, v30
    v_xor_b32 v31, 16, v30
    v_lshl_add_u32 v8, v1, 1, s24
    v_add_u32 v9, 1, v8
    v_and_b32 v8, 127, v8
    v_and_b32 v9, 127, v9
    v_lshlrev_b32 v8, 2, v8
    v_lshlrev_b32 v9, 2, v9
    s_add_u32 s39, s25, 7
    v_lshlrev_b32 v10, 1, v1
    v_add_u32 v11, 1, v10
    v_cmp_gt_u32 vcc, s39, v10
    v_cmp_gt_u32 s[76:77], s39, v11
    v_lshrrev_b32 v12, 2, v0
    v_cndmask_b32 v10, 0, 16, vcc
    v_cndmask_b32 v11, 0, 16, s[76:77]
    v_cmp_gt_u32 vcc, s39, v12
    v_cmp_gt_u32 s[76:77], s25, v12
    v_add_u32 v13, s24, v12
    v_cndmask_b32 v14, 0, 16, vcc
    v_and_b32 v13, 127, v13
    v_lshlrev_b32 v13, 2, v13
    v_mul_u32_u24 v15, 2162824, v12
    v_mov_b32 v82, 0x40000000
    v_cndmask_b32 v15, v82, v15, s[76:77]
    s_mul_i32 s39, s26, 640
    v_add_u32 v82, s39, v1
    s_mov_b32 s42, 32656
    v_lshl_add_u32 v83, v82, 3, s42
    v_lshlrev_b32 v82, 16, v82
    s_and_b32 s41, s2, 31
    s_mul_i32 s41, s41, 782
    s_mul_i32 s40, s26, 16
    s_add_u32 s41, s41, s40
    v_add_lshl_u32 v255, v1, s41, 7
    v_cmp_gt_u32 vcc, 16, v1
    v_mov_b32 v70, -16
    s_nop 0
    v_cndmask_b32 v255, v70, v255, vcc
    v_and_b32 v67, 15, v1
    v_mul_u32_u24 v67, 12, v67
    v_cmp_gt_u32 vcc, s28, v67
    v_add_u32 v66, s27, v67
    v_lshrrev_b32 v68, 4, v0
    s_mov_b32 s39, 301056
    v_mul_u32_u24 v68, s39, v68
    v_add3_u32 v68, v68, v66, -1
    v_mov_b32 v69, 0xffff
    v_cndmask_b32 v66, v69, v66, vcc
    v_mov_b32 v71, 192
    s_mov_b32 s38, 0x40000
    v_mov_b32 v195, 0x100000
    v_mov_b32 v199, 0x100000
    v_mov_b32 v203, 0x100000
    v_mov_b32 v207, 0x100000
    v_mov_b32 v211, 0x100000
    v_mov_b32 v215, 0x100000
    v_mov_b32 v219, 0x100000
    v_mov_b32 v223, 0x100000
    v_mov_b32 v227, 0x100000
    v_mov_b32 v231, 0x100000
    s_mov_b64 s[44:45], 0
    s_mov_b64 s[46:47], 0
    s_mov_b64 s[48:49], 0
    s_mov_b64 s[50:51], 0
    s_mov_b64 s[52:53], 0
    s_mov_b64 s[54:55], 0
    s_mov_b64 s[56:57], 0
    s_mov_b64 s[58:59], 0
    v_lshrrev_b32 v64, 4, v0
    v_and_b32 v65, 7, v0
    v_lshl_add_u32 v64, v64, 3, v65
    v_lshlrev_b32 v64, 6, v64
    s_lshr_b32 s31, s2, 4
    s_lshl_b32 s31, s31, 14
    s_and_b32 s40, s2, 15
    s_lshl_b32 s40, s40, 2
    s_add_u32 s31, s31, s40
    v_and_b32 v74, 63, v1
    v_lshlrev_b32 v74, 2, v74
    s_mov_b32 s41, 0x40000
P1_POLL:
    buffer_load_dword v76, v74, s[20:23], 0 offen sc1
    s_waitcnt vmcnt(0)
    v_cmp_ne_u32 vcc, 1, v76
    s_sub_u32 s41, s41, 1
    s_cbranch_scc1 K2_END
    s_cmp_eq_u64 vcc, 0
    s_cbranch_scc1 P1_RDY
    s_sleep 8
    s_branch P1_POLL
K2_OVF2:
    v_add_u32 v70, 192, v67
    v_mov_b32 v72, 0
    v_mov_b32 v73, 0
    v_sub_u32_sdwa v69, v240, v71 clamp dst_sel:DWORD dst_unused:UNUSED_PAD src0_sel:WORD_1 src1_sel:DWORD
    v_add_u32 v74, v70, v72
    s_mov_b32 s41, 384
    v_cmp_lt_u32 vcc, v74, v69
    v_add3_u32 v75, v232, v72, s41
    v_sub_u32 v72, v72, v69
    v_cndmask_b32 v73, v73, v75, vcc
    v_sub_u32_sdwa v69, v241, v71 clamp dst_sel:DWORD dst_unused:UNUSED_PAD src0_sel:WORD_1 src1_sel:DWORD
    v_add_u32 v74, v70, v72
    s_mov_b32 s41, 38016
    v_cmp_lt_u32 vcc, v74, v69
    v_add3_u32 v75, v233, v72, s41
    v_sub_u32 v72, v72, v69
    v_cndmask_b32 v73, v73, v75, vcc
    v_sub_u32_sdwa v69, v242, v71 clamp dst_sel:DWORD dst_unused:UNUSED_PAD src0_sel:WORD_1 src1_sel:DWORD
    v_add_u32 v74, v70, v72
    s_mov_b32 s41, 75648
    v_cmp_lt_u32 vcc, v74, v69
    v_add3_u32 v75, v234, v72, s41
    v_sub_u32 v72, v72, v69
    v_cndmask_b32 v73, v73, v75, vcc
    v_sub_u32_sdwa v69, v243, v71 clamp dst_sel:DWORD dst_unused:UNUSED_PAD src0_sel:WORD_1 src1_sel:DWORD
    v_add_u32 v74, v70, v72
    s_mov_b32 s41, 113280
    v_cmp_lt_u32 vcc, v74, v69
    v_add3_u32 v75, v235, v72, s41
    v_sub_u32 v72, v72, v69
    v_cndmask_b32 v73, v73, v75, vcc
    v_sub_u32_sdwa v69, v244, v71 clamp dst_sel:DWORD dst_unused:UNUSED_PAD src0_sel:WORD_1 src1_sel:DWORD
    v_add_u32 v74, v70, v72
    s_mov_b32 s41, 150912
    v_cmp_lt_u32 vcc, v74, v69
    v_add3_u32 v75, v236, v72, s41
    v_sub_u32 v72, v72, v69
    v_cndmask_b32 v73, v73, v75, vcc
    v_sub_u32_sdwa v69, v245, v71 clamp dst_sel:DWORD dst_unused:UNUSED_PAD src0_sel:WORD_1 src1_sel:DWORD
    v_add_u32 v74, v70, v72
    s_mov_b32 s41, 188544
    v_cmp_lt_u32 vcc, v74, v69
    v_add3_u32 v75, v237, v72, s41
    v_sub_u32 v72, v72, v69
    v_cndmask_b32 v73, v73, v75, vcc
    v_sub_u32_sdwa v69, v246, v71 clamp dst_sel:DWORD dst_unused:UNUSED_PAD src0_sel:WORD_1 src1_sel:DWORD
    v_add_u32 v74, v70, v72
    s_mov_b32 s41, 226176
    v_cmp_lt_u32 vcc, v74, v69
    v_add3_u32 v75, v238, v72, s41
    v_sub_u32 v72, v72, v69
    v_cndmask_b32 v73, v73, v75, vcc
    v_sub_u32_sdwa v69, v247, v71 clamp dst_sel:DWORD dst_unused:UNUSED_PAD src0_sel:WORD_1 src1_sel:DWORD
    v_add_u32 v74, v70, v72
    s_mov_b32 s41, 263808
    v_cmp_lt_u32 vcc, v74, v69
    v_add3_u32 v75, v239, v72, s41
    v_sub_u32 v72, v72, v69
    v_cndmask_b32 v73, v73, v75, vcc
    s_mov_b64 exec, s[62:63]
    buffer_load_dwordx3 v[228:230], v73, s[12:15], s38 offen sc1
    s_mov_b64 exec, -1
    s_waitcnt vmcnt(0)
    s_branch K2_OVFD
K2_NEXT:
    v_lshlrev_b32 v64, 2, v0
    v_mov_b32 v66, 0
    s_movk_i32 s42, 132
    v_cmp_gt_u32 vcc, s42, v0
    s_mov_b64 exec, vcc
    ds_write_b32 v64, v66 offset:0
    s_mov_b64 exec, -1
    v_lshl_add_u32 v8, v1, 1, s24
    v_add_u32 v9, 1, v8
    v_and_b32 v8, 127, v8
    v_and_b32 v9, 127, v9
    v_lshlrev_b32 v8, 2, v8
    v_lshlrev_b32 v9, 2, v9
    s_add_u32 s39, s25, 7
    v_lshlrev_b32 v10, 1, v1
    v_add_u32 v11, 1, v10
    v_cmp_gt_u32 vcc, s39, v10
    v_cmp_gt_u32 s[76:77], s39, v11
    v_lshrrev_b32 v12, 2, v0
    v_cndmask_b32 v10, 0, 16, vcc
    v_cndmask_b32 v11, 0, 16, s[76:77]
    v_cmp_gt_u32 vcc, s39, v12
    v_cmp_gt_u32 s[76:77], s25, v12
    v_add_u32 v13, s24, v12
    v_cndmask_b32 v14, 0, 16, vcc
    v_and_b32 v13, 127, v13
    v_lshlrev_b32 v13, 2, v13
    v_mul_u32_u24 v15, 2162824, v12
    v_mov_b32 v82, 0x40000000
    v_cndmask_b32 v15, v82, v15, s[76:77]
    s_mul_i32 s39, s26, 640
    v_add_u32 v82, s39, v1
    s_mov_b32 s42, 32656
    v_lshl_add_u32 v83, v82, 3, s42
    v_lshlrev_b32 v82, 16, v82
    s_and_b32 s41, s2, 31
    s_mul_i32 s41, s41, 782
    s_mul_i32 s40, s26, 16
    s_add_u32 s41, s41, s40
    v_add_lshl_u32 v255, v1, s41, 7
    v_cmp_gt_u32 vcc, 16, v1
    v_mov_b32 v70, -16
    s_nop 0
    v_cndmask_b32 v255, v70, v255, vcc
    v_and_b32 v67, 15, v1
    v_mul_u32_u24 v67, 12, v67
    v_cmp_gt_u32 vcc, s28, v67
    v_add_u32 v66, s27, v67
    v_lshrrev_b32 v68, 4, v0
    s_mov_b32 s39, 301056
    v_mul_u32_u24 v68, s39, v68
    v_add3_u32 v68, v68, v66, -1
    v_mov_b32 v69, 0xffff
    v_cndmask_b32 v66, v69, v66, vcc
    v_mov_b32 v71, 192
    s_mov_b32 s38, 0x40000
    v_mov_b32 v195, 0x100000
    v_mov_b32 v199, 0x100000
    v_mov_b32 v203, 0x100000
    v_mov_b32 v207, 0x100000
    v_mov_b32 v211, 0x100000
    v_mov_b32 v215, 0x100000
    v_mov_b32 v219, 0x100000
    v_mov_b32 v223, 0x100000
    v_mov_b32 v227, 0x100000
    v_mov_b32 v231, 0x100000
    s_mov_b64 s[44:45], 0
    s_mov_b64 s[46:47], 0
    s_mov_b64 s[48:49], 0
    s_mov_b64 s[50:51], 0
    s_mov_b64 s[52:53], 0
    s_mov_b64 s[54:55], 0
    s_mov_b64 s[56:57], 0
    s_mov_b64 s[58:59], 0
    v_lshrrev_b32 v64, 4, v0
    v_and_b32 v65, 7, v0
    v_lshl_add_u32 v64, v64, 3, v65
    v_lshlrev_b32 v64, 6, v64
    s_lshr_b32 s31, s2, 4
    s_lshl_b32 s31, s31, 14
    s_and_b32 s40, s2, 15
    s_lshl_b32 s40, s40, 2
    s_add_u32 s31, s31, s40
    buffer_load_dword v65, v64, s[12:15], s31 offen sc1
    s_waitcnt lgkmcnt(0)
    s_barrier
    s_branch K2_ROUND
K2_TAIL2:
    v_cmp_gt_u32 vcc, s41, v11
    v_add_u32 v12, v13, v11
    v_add_u32 v15, v14, v11
    s_mov_b64 exec, vcc
    ds_read_b128 v[224:227], v12 offset:0
    ds_read_b128 v[228:231], v12 offset:16
    ds_read_b128 v[232:235], v12 offset:32
    ds_read_b128 v[236:239], v12 offset:48
    ds_read_b128 v[240:243], v15 offset:64
    ds_read_b128 v[244:247], v15 offset:80
    ds_read_b128 v[248:251], v15 offset:96
    ds_read_b128 v[252:255], v15 offset:112
    s_waitcnt lgkmcnt(7)
    v_pk_add_f32 v[192:193], v[192:193], v[224:225]
    v_pk_add_f32 v[194:195], v[194:195], v[226:227]
    s_waitcnt lgkmcnt(6)
    v_pk_add_f32 v[196:197], v[196:197], v[228:229]
    v_pk_add_f32 v[198:199], v[198:199], v[230:231]
    s_waitcnt lgkmcnt(5)
    v_pk_add_f32 v[200:201], v[200:201], v[232:233]
    v_pk_add_f32 v[202:203], v[202:203], v[234:235]
    s_waitcnt lgkmcnt(4)
    v_pk_add_f32 v[204:205], v[204:205], v[236:237]
    v_pk_add_f32 v[206:207], v[206:207], v[238:239]
    s_waitcnt lgkmcnt(3)
    v_pk_add_f32 v[208:209], v[208:209], v[240:241]
    v_pk_add_f32 v[210:211], v[210:211], v[242:243]
    s_waitcnt lgkmcnt(2)
    v_pk_add_f32 v[212:213], v[212:213], v[244:245]
    v_pk_add_f32 v[214:215], v[214:215], v[246:247]
    s_waitcnt lgkmcnt(1)
    v_pk_add_f32 v[216:217], v[216:217], v[248:249]
    v_pk_add_f32 v[218:219], v[218:219], v[250:251]
    s_waitcnt lgkmcnt(0)
    v_pk_add_f32 v[220:221], v[220:221], v[252:253]
    v_pk_add_f32 v[222:223], v[222:223], v[254:255]
    s_mov_b64 exec, s[78:79]
    s_branch K2_TAIL2D
K2_TAILAT:
    s_waitcnt lgkmcnt(0)
    s_barrier
    s_bfe_i32 exec_lo, s76, 0x10000
    s_bfe_i32 exec_hi, s77, 0x10000
    ds_add_f32 v65, v84 offset:0
    ds_add_f32 v65, v85 offset:4
    ds_add_f32 v65, v86 offset:8
    ds_add_f32 v65, v87 offset:12
    s_bfe_i32 exec_lo, s76, 0x10004
    s_bfe_i32 exec_hi, s77, 0x10004
    ds_add_f32 v66, v88 offset:0
    ds_add_f32 v66, v89 offset:4
    ds_add_f32 v66, v90 offset:8
    ds_add_f32 v66, v91 offset:12
    s_bfe_i32 exec_lo, s76, 0x10008
    s_bfe_i32 exec_hi, s77, 0x10008
    ds_add_f32 v70, v92 offset:0
    ds_add_f32 v70, v93 offset:4
    ds_add_f32 v70, v94 offset:8
    ds_add_f32 v70, v95 offset:12
    s_bfe_i32 exec_lo, s76, 0x1000c
    s_bfe_i32 exec_hi, s77, 0x1000c
    ds_add_f32 v71, v96 offset:0
    ds_add_f32 v71, v97 offset:4
    ds_add_f32 v71, v98 offset:8
    ds_add_f32 v71, v99 offset:12
    s_branch K2_TAILD
K2_FAIL:
    s_movk_i32 s28, 144
    s_waitcnt vmcnt(0) lgkmcnt(0)
    s_barrier
    s_branch K2_NEXT
K2_SLOWTOT:
    s_mov_b64 exec, -1
    v_lshlrev_b32 v14, 7, v0
    s_lshl_b32 s40, s2, 16
    s_add_u32 s40, s40, 17825792
    s_waitcnt lgkmcnt(0)
    s_cmp_lg_u32 s29, 0
    s_cbranch_scc1 K2_ST1
    buffer_load_dwordx4 v[224:227], v14, s[12:15], s40 offen offset:0 sc1
    buffer_load_dwordx4 v[228:231], v14, s[12:15], s40 offen offset:16 sc1
    buffer_load_dwordx4 v[232:235], v14, s[12:15], s40 offen offset:32 sc1
    buffer_load_dwordx4 v[236:239], v14, s[12:15], s40 offen offset:48 sc1
    buffer_load_dwordx4 v[240:243], v14, s[12:15], s40 offen offset:64 sc1
    buffer_load_dwordx4 v[244:247], v14, s[12:15], s40 offen offset:80 sc1
    buffer_load_dwordx4 v[248:251], v14, s[12:15], s40 offen offset:96 sc1
    buffer_load_dwordx4 v[252:255], v14, s[12:15], s40 offen offset:112 sc1
    s_waitcnt vmcnt(0)
    v_add_f32 v192, v192, v224
    v_add_f32 v193, v193, v225
    v_add_f32 v194, v194, v226
    v_add_f32 v195, v195, v227
    v_add_f32 v196, v196, v228
    v_add_f32 v197, v197, v229
    v_add_f32 v198, v198, v230
    v_add_f32 v199, v199, v231
    v_add_f32 v200, v200, v232
    v_add_f32 v201, v201, v233
    v_add_f32 v202, v202, v234
    v_add_f32 v203, v203, v235
    v_add_f32 v204, v204, v236
    v_add_f32 v205, v205, v237
    v_add_f32 v206, v206, v238
    v_add_f32 v207, v207, v239
    v_add_f32 v208, v208, v240
    v_add_f32 v209, v209, v241
    v_add_f32 v210, v210, v242
    v_add_f32 v211, v211, v243
    v_add_f32 v212, v212, v244
    v_add_f32 v213, v213, v245
    v_add_f32 v214, v214, v246
    v_add_f32 v215, v215, v247
    v_add_f32 v216, v216, v248
    v_add_f32 v217, v217, v249
    v_add_f32 v218, v218, v250
    v_add_f32 v219, v219, v251
    v_add_f32 v220, v220, v252
    v_add_f32 v221, v221, v253
    v_add_f32 v222, v222, v254
    v_add_f32 v223, v223, v255
    s_cmp_eq_u32 s36, 0
    s_cbranch_scc1 K2_FIN
K2_ST1:
    buffer_store_dwordx4 v[192:195], v14, s[12:15], s40 offen offset:0 sc1
    buffer_store_dwordx4 v[196:199], v14, s[12:15], s40 offen offset:16 sc1
    buffer_store_dwordx4 v[200:203], v14, s[12:15], s40 offen offset:32 sc1
    buffer_store_dwordx4 v[204:207], v14, s[12:15], s40 offen offset:48 sc1
    buffer_store_dwordx4 v[208:211], v14, s[12:15], s40 offen offset:64 sc1
    buffer_store_dwordx4 v[212:215], v14, s[12:15], s40 offen offset:80 sc1
    buffer_store_dwordx4 v[216:219], v14, s[12:15], s40 offen offset:96 sc1
    buffer_store_dwordx4 v[220:223], v14, s[12:15], s40 offen offset:112 sc1
    s_mov_b32 s29, 0
    s_add_u32 s27, s27, s28
    s_waitcnt vmcnt(0)
    s_barrier
    s_branch K2_NEXT
K2_CODE_END:
.section .rodata,"a"
.p2align 6
.amdhsa_kernel standalone__edge_featured_mpnn_gatedgcn__graph_kernel
  .amdhsa_next_free_vgpr 256
  .amdhsa_next_free_sgpr 102
  .amdhsa_accum_offset 256
  .amdhsa_group_segment_fixed_size 0
  .amdhsa_kernarg_size 96
  .amdhsa_user_sgpr_count 2
  .amdhsa_user_sgpr_kernarg_segment_ptr 1
  .amdhsa_system_sgpr_workgroup_id_x 1
.end_amdhsa_kernel
```
